```python
import torch

def _softmax(x, axis=-1):
    return torch.softmax(x, dim=axis)
def _gelu(x):
    return torch.nn.functional.gelu(x, approximate="tanh")
def _silu(x):
    return torch.nn.functional.silu(x)
def _sigmoid(x):
    return torch.sigmoid(x)
def _layernorm(x, axis=-1, eps=1e-5):
    m = x.mean(dim=axis, keepdim=True)
    v = x.var(dim=axis, keepdim=True, unbiased=False)
    return (x - m) / torch.sqrt(v + eps)
def _scatter_add(tgt, idx, src, axis=0):
    return tgt.clone().index_add_(axis, idx, src)
def _segment_sum(src, seg, n):
    out = torch.zeros((n,) + src.shape[1:], dtype=src.dtype)
    return out.index_add_(0, seg, src)
def _pad(x, pw):
    flat = tuple(v for pair in reversed(pw) for v in pair)
    return torch.nn.functional.pad(x, flat)

kernel_name = 'gated_mix__linear_attn_block__dense_activation_relu__prompt'

def setup_inputs():

    _w = (lambda a: (lambda t: t.to(torch.bfloat16) if t.is_floating_point() else t)(torch.as_tensor(a)))
    def _A_setup():
        B, S, D = 1, 2048, 512
        return {
            "x": _w((lambda *s: torch.randn(*s, dtype=torch.bfloat16) * 0.05)(B, S, D)),
            "wqkv": _w((lambda *s: torch.randn(*s, dtype=torch.bfloat16) * 0.8)(D, 3 * D)),
            "wo": _w((lambda *s: torch.randn(*s, dtype=torch.bfloat16) * 0.2)(D, D)),
        }
    _A_in = _A_setup()

    def _B_setup():
        B, S, D, Dff = 1, 2048, 512, 1792
        return {
            "x": _w((lambda *s: torch.randn(*s, dtype=torch.bfloat16) * 0.05)(B, S, D)),
            "w1": _w((lambda *s: torch.randn(*s, dtype=torch.bfloat16) * 0.05)(D, Dff)),
            "w2": _w((lambda *s: torch.randn(*s, dtype=torch.bfloat16) * 0.05)(Dff, D)),
        }
    _B_in = _B_setup()

    return {
        "A_x": _A_in["x"],
        "A_wqkv": _A_in["wqkv"],
        "A_wo": _A_in["wo"],
        "B_x": _B_in["x"],
        "B_w1": _B_in["w1"],
        "B_w2": _B_in["w2"],
        "gate_w": _w((lambda *s: torch.randn(*s, dtype=torch.bfloat16) * 0.05)(512) * 16.0),
    }

def reference(A_x, A_wqkv, A_wo, B_x, B_w1, B_w2, gate_w):
    def _A_ref(x, wqkv, wo):
        B, S, D = x.shape
        H = 32; Dh = D // H
        qkv = (lambda x, *d: x.permute(*d))((x @ wqkv).reshape(B, S, 3, H, Dh), 2, 0, 3, 1, 4)
        q, k, v = qkv[0], qkv[1], qkv[2]
        phi = lambda t: torch.where(t > 0, t + 1, torch.exp(t)) + 1e-6
        pq, pk = phi(q), phi(k)
        kv = torch.einsum("bhsd,bhse->bhde", pk, v)
        z = torch.einsum("bhsd->bhd", pk)
        num = torch.einsum("bhqd,bhde->bhqe", pq, kv)
        den = torch.einsum("bhqd,bhd->bhq", pq, z)[..., None] + 1e-6
        o = num / den
        return (lambda x, *d: x.permute(*d))(o, 0, 2, 1, 3).reshape(B, S, D) @ wo

    def _B_ref(x, w1, w2):
        h = torch.einsum("bsd,df->bsf", x, w1)
        zero = torch.zeros_like(h)
        h = torch.maximum(h, zero)
        return torch.einsum("bsf,fd->bsd", h, w2)

    x = A_x
    g = _sigmoid((x * gate_w).sum(-1, keepdims=True))
    a = _A_ref(x, A_wqkv, A_wo)
    b = _B_ref(x, B_w1, B_w2)
    return g * a + (1 - g) * b
```

```asm
; @launch grid=(256,1,1) block=(512,1,1) lds=163840
.amdgcn_target "amdgcn-amd-amdhsa--gfx950"
.text
.globl gated_mix__linear_attn_block__dense_activation_relu__prompt_kernel
.p2align 8
.type gated_mix__linear_attn_block__dense_activation_relu__prompt_kernel,@function
gated_mix__linear_attn_block__dense_activation_relu__prompt_kernel:
s_load_dwordx2 s[4:5], s[0:1], 0
s_load_dwordx2 s[74:75], s[0:1], 8
s_load_dwordx2 s[76:77], s[0:1], 32
s_lshr_b32 s44, s2, 6
v_readfirstlane_b32 s40, v0
s_cmp_gt_u32 s44, 3
s_cbranch_scc1 Lend
v_lshrrev_b32 v23, 3, v0
s_lshr_b32 s56, s2, 3
v_and_b32 v24, 56, v23
s_and_b32 s56, s56, 7
v_and_b32 v25, 7, v23
s_and_b32 s55, s2, 1
v_lshl_add_u32 v24, v24, 1, v25
s_lshl3_add_u32 s43, s55, s56
v_bfe_u32 v26, v0, 4, 2
s_lshr_b32 s45, s2, 1
v_and_b32 v27, 7, v0
s_xor_b32 s55, s55, s45
v_xor_b32 v28, v27, v26
s_and_b32 s45, s45, 3
v_lshlrev_b32 v28, 4, v28
s_lshl_b32 s55, s55, 2
v_lshl_add_u32 v2, v24, 10, v28
s_and_b32 s89, s55, 4
v_and_b32 v33, 35, v23
s_sub_u32 s47, s44, s56
v_and_b32 v24, 12, v23
s_and_b32 s47, s47, 3
v_lshl_add_u32 v33, v24, 1, v33
s_cselect_b32 s52, 0, 1
v_bfe_u32 v24, v0, 7, 1
s_add_u32 s52, s52, s89
v_lshl_add_u32 v33, v24, 2, v33
s_lshl_b32 s49, s43, 17
v_lshlrev_b32 v29, 1, v26
s_lshl_b32 s48, s40, 6
v_xor_b32 v29, v27, v29
s_mov_b32 m0, s48
v_lshlrev_b32 v29, 4, v29
s_lshl_b32 s93, s52, 7
v_xor_b32 v3, 64, v2
s_add_u32 s93, s93, s49
v_add_u32 v3, 7168, v3
s_lshr_b32 s53, s44, 1
s_lshl1_add_u32 s46, s45, s53
s_mul_i32 s54, s45, 7
s_lshl2_add_u32 s55, s53, s53
s_add_u32 s54, s54, s55
s_add_u32 s50, s46, 8
s_and_b32 s55, s44, 1
s_cmp_lg_u32 s55, s53
s_cselect_b32 s50, s50, s54
s_cselect_b32 s3, 48, 56
s_cselect_b32 s53, 8, 1
s_cselect_b32 s80, 1, 2
v_mul_u32_u24 v4, s3, v33
s_mov_b32 s7, 0x00020000
v_lshl_add_u32 v4, v4, 6, v29
s_movk_i32 s6, 0x400
v_lshl_add_u32 v5, s53, 7, v4
s_mov_b32 s11, s7
v_add_u32 v4, s6, v4
s_mul_i32 s94, s52, s3
s_waitcnt lgkmcnt(0)
s_cselect_b64 s[8:9], s[74:75], s[76:77]
s_cselect_b64 s[12:13], s[76:77], s[74:75]
s_lshl_b32 s6, s7, 4
buffer_load_dwordx4 v2, s[4:7], s93 offen offset:0 lds
s_sub_u32 s8, s8, 4096
s_subb_u32 s9, s9, 0
buffer_load_dwordx4 v3, s[4:7], s93 offen offset:1024 lds
s_add_u32 s50, s50, 8
s_lshl_b32 s94, s94, 5
s_lshl3_add_u32 s10, s3, 1
s_add_u32 s94, s94, s50
s_lshl_b32 s10, s10, 12
s_lshl_b32 s94, s94, 7
buffer_load_dwordx4 v4, s[8:11], s94 offen offset:2048 lds
buffer_load_dwordx4 v5, s[8:11], s94 offen offset:3072 lds
s_getpc_b64 s[78:79]
Lpc:
v_lshrrev_b32 v23, 6, v0
s_and_b32 s53, s2, 0xf8
v_add_lshl_u32 v23, v23, s53, 7
v_min_u32 v23, (Lend-Lpc), v23
v_mov_b32 v25, s79
v_add_co_u32 v24, vcc, s78, v23
s_nop 1
v_addc_co_u32 v25, vcc, 0, v25, vcc
global_load_dword v35, v[24:25], off
s_mov_b32 s55, s47
s_mov_b32 s47, 1984246273
s_lshl_b32 s50, s50, 7
s_lshl_b32 s3, s3, 12
s_cmp_eq_u32 s55, 1
s_cselect_b32 s47, 1969500448, s47
s_cmp_eq_u32 s55, 2
s_cselect_b32 s47, 1733567248, s47
s_cmp_eq_u32 s55, 3
s_cselect_b32 s47, 1985167888, s47
s_load_dwordx2 s[24:25], s[0:1], 72
s_load_dwordx2 s[36:37], s[0:1], 48
s_load_dwordx2 s[32:33], s[0:1], 64
s_load_dwordx2 s[16:17], s[0:1], 16
s_load_dwordx2 s[20:21], s[0:1], 40
s_load_dwordx2 s[28:29], s[0:1], 56
s_lshr_b32 s40, s40, 6
v_and_b32 v1, 63, v0
s_lshr_b32 s42, s40, 2
s_and_b32 s41, s40, 3
v_lshlrev_b32 v15, 4, v1
s_xor_b32 s92, s89, 4
s_sub_u32 s14, 3416064, s10
s_mov_b32 s15, 0x00020000
s_mov_b32 s26, 0x10000000
s_mov_b32 s27, 0x00020000
v_bfe_u32 v30, v0, 3, 2
v_bfe_u32 v26, v0, 5, 1
v_lshl_add_u32 v30, v26, 2, v30
s_lshl_b32 s53, s42, 3
v_add_u32 v30, s53, v30
v_lshl_add_u32 v16, v30, 10, v29
v_add_u32 v17, 15360, v16
v_and_b32 v23, 15, v1
v_lshrrev_b32 v24, 4, v1
v_lshrrev_b32 v25, 1, v23
v_xor_b32 v25, v25, v24
v_lshlrev_b32 v25, 4, v25
v_lshl_add_u32 v25, v23, 7, v25
s_lshl_b32 s53, s41, 13
v_add_u32 v7, s53, v25
v_xor_b32 v8, 64, v7
v_bfe_u32 v25, v1, 2, 3
v_lshlrev_b32 v25, 7, v25
v_and_b32 v26, 3, v1
v_lshl_add_u32 v25, v26, 3, v25
v_bfe_u32 v26, v1, 3, 2
v_lshl_add_u32 v25, v26, 5, v25
v_lshrrev_b32 v27, 5, v1
v_lshl_add_u32 v28, v27, 12, v25
s_lshl_b32 s53, s42, 6
v_xor_b32 v9, s53, v28
v_xor_b32 v10, 32, v9
s_mov_b32 s67, 0x358637bd
s_mov_b32 s34, 256
s_mov_b32 s35, 0x00020000
s_mov_b32 s38, 1024
s_mov_b32 s39, 0x00020000
v_mov_b32 v36, s67
v_mov_b32 v37, s67
v_mov_b32 v38, s67
v_mov_b32 v39, s67
s_waitcnt lgkmcnt(0)
s_cmp_lg_u32 s2, 64
s_cbranch_scc1 Lnl1
s_cmp_lg_u32 s40, 7
s_cbranch_scc1 Lnl1
v_lshrrev_b32 v31, 2, v1
v_and_b32 v32, 3, v1
v_lshlrev_b32 v32, 4, v32
v_lshl_add_u32 v31, v31, 8, v32
s_mov_b32 s53, 0
buffer_load_dwordx4 v[240:243], v31, s[24:27], s53 offen sc1
s_mov_b32 s53, 4096
buffer_load_dwordx4 v[244:247], v31, s[24:27], s53 offen sc1
s_mov_b32 s53, 8192
buffer_load_dwordx4 v[248:251], v31, s[24:27], s53 offen sc1
s_mov_b32 s53, 12288
buffer_load_dwordx4 v[252:255], v31, s[24:27], s53 offen sc1
Lnl1:
s_and_b32 s95, s44, 2
s_add_u32 s95, s95, s42
s_lshl_b32 s95, s95, 5
v_xor_b32 v11, s95, v28
s_mul_i32 s81, s45, 896
s_lshl_b32 s95, s44, 8
s_add_u32 s95, s95, s81
s_lshl_b32 s96, s46, 7
s_cmp_eq_u32 s80, 1
s_cselect_b32 s51, s95, s96
s_add_u32 s51, s51, 4096
s_add_u32 s81, s81, 4352
v_and_b32 v26, 3, v1
s_lshl_b32 s95, s41, 2
v_add_u32 v26, s95, v26
v_lshlrev_b32 v12, 2, v26
s_lshl2_add_u32 s95, s45, s44
s_lshl_b32 s82, s95, 2
v_lshl_add_u32 v28, v27, 10, v25
s_lshl_b32 s95, s41, 12
v_add_u32 v18, s95, v28
v_xor_b32 v19, 32, v18
v_xor_b32 v20, 64, v18
v_xor_b32 v21, 96, v18
s_sub_u32 s12, s12, 4096
s_subb_u32 s13, s13, 0
v_and_b32 v26, 31, v1
v_lshlrev_b32 v26, 4, v26
v_mul_u32_u24 v27, 73728, v27
v_add_u32 v14, v26, v27
s_lshl_b32 s95, s43, 3
s_lshl_b32 s96, s41, 1
s_add_u32 s95, s95, s96
s_mul_i32 s57, s95, 73728
s_add_u32 s57, s57, 1048576
s_and_b32 s95, s2, 7
s_lshr_b32 s96, s2, 3
s_and_b32 s97, s96, 3
s_lshl_b32 s59, s95, 2
s_add_u32 s59, s59, s97
s_lshr_b32 s60, s96, 2
s_lshl_b32 s95, s59, 2
s_lshl_b32 s96, s42, 1
s_add_u32 s95, s95, s96
s_mul_i32 s62, s95, 73728
s_add_u32 s62, s62, 1048576
s_lshl_b32 s63, s60, 7
s_add_u32 s63, s63, 4096
s_lshl_b32 s64, s46, 2
s_lshr_b32 s65, s59, 1
s_lshl_b32 s65, s65, 8
v_and_b32 v26, 1, v1
s_lshl_b32 s95, s41, 1
v_add_u32 v26, s95, v26
v_lshlrev_b32 v22, 2, v26
s_mov_b32 s66, 0x3fb8aa3b
s_mov_b32 s68, 0xb5c1a2a0
s_sub_u32 s16, s16, 4096
s_subb_u32 s17, s17, 0
s_mov_b32 s18, 528384
s_mov_b32 s19, 0x00020000
s_sub_u32 s20, s20, 4096
s_subb_u32 s21, s21, 0
s_mov_b32 s22, 1839104
s_mov_b32 s23, 0x00020000
s_mov_b32 s30, 2097152
s_mov_b32 s31, 0x00020000
s_lshr_b32 s53, s82, 2
s_lshl4_add_u32 s53, s43, s53
s_lshl3_add_u32 s69, s53, s40
s_lshl_b32 s78, s69, 10
s_add_u32 m0, s48, 32768
s_bfe_u32 s52, s47, 262148
s_add_u32 s52, s52, s89
s_and_b32 s52, s52, 7
s_lshl_b32 s93, s52, 7
s_add_u32 s93, s93, s49
buffer_load_dwordx4 v2, s[4:7], s93 offen offset:0 lds
s_mul_i32 s94, s52, s3
s_add_u32 s94, s94, s50
buffer_load_dwordx4 v4, s[8:11], s94 offen offset:2048 lds
buffer_load_dwordx4 v3, s[4:7], s93 offen offset:1024 lds
buffer_load_dwordx4 v5, s[8:11], s94 offen offset:3072 lds
s_cmp_eq_u32 s80, 2
s_cbranch_scc1 LT2
s_waitcnt vmcnt(4)
s_barrier
ds_read_b128 v[128:131], v7 offset:0
ds_read_b64_tr_b16 v[40:41], v9 offset:2048
ds_read_b64_tr_b16 v[42:43], v9 offset:10240
ds_read_b128 v[132:135], v7 offset:4096
ds_read_b64_tr_b16 v[44:45], v10 offset:2048
ds_read_b64_tr_b16 v[46:47], v10 offset:10240
ds_read_b64_tr_b16 v[48:49], v9 offset:3072
ds_read_b64_tr_b16 v[50:51], v9 offset:11264
ds_read_b64_tr_b16 v[52:53], v10 offset:3072
ds_read_b64_tr_b16 v[54:55], v10 offset:11264
s_waitcnt lgkmcnt(7)
v_mfma_f32_16x16x32_bf16 v[96:99], v[128:131], v[40:43], v[36:39]
ds_read_b128 v[136:139], v8 offset:0
ds_read_b64_tr_b16 v[56:57], v9 offset:18432
s_add_u32 m0, s48, 65536
s_bfe_u32 s52, s47, 262152
s_add_u32 s52, s52, s89
s_and_b32 s52, s52, 7
s_lshl_b32 s93, s52, 7
s_add_u32 s93, s93, s49
buffer_load_dwordx4 v2, s[4:7], s93 offen offset:0 lds
s_waitcnt lgkmcnt(8)
v_mfma_f32_16x16x32_bf16 v[100:103], v[132:135], v[40:43], v[36:39]
ds_read_b64_tr_b16 v[58:59], v9 offset:26624
ds_read_b128 v[140:143], v8 offset:4096
s_waitcnt lgkmcnt(8)
v_mfma_f32_16x16x32_bf16 v[104:107], v[128:131], v[44:47], v[36:39]
ds_read_b64_tr_b16 v[60:61], v10 offset:18432
ds_read_b64_tr_b16 v[62:63], v10 offset:26624
s_mul_i32 s94, s52, s3
s_add_u32 s94, s94, s50
buffer_load_dwordx4 v4, s[8:11], s94 offen offset:2048 lds
v_mfma_f32_16x16x32_bf16 v[108:111], v[132:135], v[44:47], v[36:39]
ds_read_b64_tr_b16 v[64:65], v9 offset:19456
ds_read_b64_tr_b16 v[66:67], v9 offset:27648
s_waitcnt lgkmcnt(10)
v_mfma_f32_16x16x32_bf16 v[112:115], v[128:131], v[48:51], 0
ds_read_b64_tr_b16 v[68:69], v10 offset:19456
ds_read_b64_tr_b16 v[70:71], v10 offset:27648
buffer_load_dwordx4 v3, s[4:7], s93 offen offset:1024 lds
v_mfma_f32_16x16x32_bf16 v[116:119], v[132:135], v[48:51], 0
s_waitcnt lgkmcnt(10)
v_mfma_f32_16x16x32_bf16 v[120:123], v[128:131], v[52:55], 0
buffer_load_dwordx4 v5, s[8:11], s94 offen offset:3072 lds
v_mfma_f32_16x16x32_bf16 v[124:127], v[132:135], v[52:55], 0
s_waitcnt vmcnt(4) lgkmcnt(0)
s_barrier
s_cmp_lg_u32 s2, 64
s_cbranch_scc1 Lnp2
s_cmp_lg_u32 s40, 7
s_cbranch_scc1 Lnp2
s_mov_b32 s53, 0
Lnpl3:
s_add_u32 s53, s53, 1
s_mov_b64 s[54:55], 0
v_cmp_eq_u32 vcc, s53, v240
s_nop 0
s_or_b64 s[54:55], s[54:55], vcc
v_cmp_eq_u32 vcc, s53, v241
s_nop 0
s_or_b64 s[54:55], s[54:55], vcc
v_cmp_eq_u32 vcc, s53, v242
s_nop 0
s_or_b64 s[54:55], s[54:55], vcc
v_cmp_eq_u32 vcc, s53, v243
s_nop 0
s_or_b64 s[54:55], s[54:55], vcc
v_cmp_eq_u32 vcc, s53, v244
s_nop 0
s_or_b64 s[54:55], s[54:55], vcc
v_cmp_eq_u32 vcc, s53, v245
s_nop 0
s_or_b64 s[54:55], s[54:55], vcc
v_cmp_eq_u32 vcc, s53, v246
s_nop 0
s_or_b64 s[54:55], s[54:55], vcc
v_cmp_eq_u32 vcc, s53, v247
s_nop 0
s_or_b64 s[54:55], s[54:55], vcc
v_cmp_eq_u32 vcc, s53, v248
s_nop 0
s_or_b64 s[54:55], s[54:55], vcc
v_cmp_eq_u32 vcc, s53, v249
s_nop 0
s_or_b64 s[54:55], s[54:55], vcc
v_cmp_eq_u32 vcc, s53, v250
s_nop 0
s_or_b64 s[54:55], s[54:55], vcc
v_cmp_eq_u32 vcc, s53, v251
s_nop 0
s_or_b64 s[54:55], s[54:55], vcc
v_cmp_eq_u32 vcc, s53, v252
s_nop 0
s_or_b64 s[54:55], s[54:55], vcc
v_cmp_eq_u32 vcc, s53, v253
s_nop 0
s_or_b64 s[54:55], s[54:55], vcc
v_cmp_eq_u32 vcc, s53, v254
s_nop 0
s_or_b64 s[54:55], s[54:55], vcc
v_cmp_eq_u32 vcc, s53, v255
s_nop 0
s_or_b64 s[54:55], s[54:55], vcc
s_cbranch_scc1 Lnpl3
v_mov_b32 v31, s53
v_mov_b32 v32, 2147483648
v_writelane_b32 v32, 0, 0
buffer_store_dword v31, v32, s[32:35], 0 offen sc1
Lnp2:
v_mfma_f32_16x16x32_bf16 v[96:99], v[136:139], v[56:59], v[96:99]
ds_read_b128 v[144:147], v7 offset:32768
ds_read_b64_tr_b16 v[40:41], v9 offset:34816
s_add_u32 m0, s48, 98304
s_bfe_u32 s52, s47, 262156
s_add_u32 s52, s52, s89
s_and_b32 s52, s52, 7
s_lshl_b32 s93, s52, 7
s_add_u32 s93, s93, s49
buffer_load_dwordx4 v2, s[4:7], s93 offen offset:0 lds
v_mfma_f32_16x16x32_bf16 v[100:103], v[140:143], v[56:59], v[100:103]
ds_read_b64_tr_b16 v[42:43], v9 offset:43008
ds_read_b128 v[148:151], v7 offset:36864
v_mfma_f32_16x16x32_bf16 v[104:107], v[136:139], v[60:63], v[104:107]
ds_read_b64_tr_b16 v[44:45], v10 offset:34816
ds_read_b64_tr_b16 v[46:47], v10 offset:43008
v_mfma_f32_16x16x32_bf16 v[108:111], v[140:143], v[60:63], v[108:111]
ds_read_b64_tr_b16 v[48:49], v9 offset:35840
ds_read_b64_tr_b16 v[50:51], v9 offset:44032
v_mfma_f32_16x16x32_bf16 v[112:115], v[136:139], v[64:67], v[112:115]
ds_read_b64_tr_b16 v[52:53], v10 offset:35840
ds_read_b64_tr_b16 v[54:55], v10 offset:44032
s_mul_i32 s94, s52, s3
s_add_u32 s94, s94, s50
buffer_load_dwordx4 v4, s[8:11], s94 offen offset:2048 lds
v_mfma_f32_16x16x32_bf16 v[116:119], v[140:143], v[64:67], v[116:119]
v_mfma_f32_16x16x32_bf16 v[120:123], v[136:139], v[68:71], v[120:123]
v_mfma_f32_16x16x32_bf16 v[124:127], v[140:143], v[68:71], v[124:127]
s_waitcnt lgkmcnt(7)
v_mfma_f32_16x16x32_bf16 v[96:99], v[144:147], v[40:43], v[96:99]
ds_read_b128 v[152:155], v8 offset:32768
ds_read_b64_tr_b16 v[56:57], v9 offset:51200
buffer_load_dwordx4 v3, s[4:7], s93 offen offset:1024 lds
s_waitcnt lgkmcnt(8)
v_mfma_f32_16x16x32_bf16 v[100:103], v[148:151], v[40:43], v[100:103]
ds_read_b64_tr_b16 v[58:59], v9 offset:59392
ds_read_b128 v[156:159], v8 offset:36864
s_waitcnt lgkmcnt(8)
v_mfma_f32_16x16x32_bf16 v[104:107], v[144:147], v[44:47], v[104:107]
ds_read_b64_tr_b16 v[60:61], v10 offset:51200
ds_read_b64_tr_b16 v[62:63], v10 offset:59392
v_mfma_f32_16x16x32_bf16 v[108:111], v[148:151], v[44:47], v[108:111]
ds_read_b64_tr_b16 v[64:65], v9 offset:52224
ds_read_b64_tr_b16 v[66:67], v9 offset:60416
s_waitcnt lgkmcnt(10)
v_mfma_f32_16x16x32_bf16 v[112:115], v[144:147], v[48:51], v[112:115]
ds_read_b64_tr_b16 v[68:69], v10 offset:52224
ds_read_b64_tr_b16 v[70:71], v10 offset:60416
buffer_load_dwordx4 v5, s[8:11], s94 offen offset:3072 lds
v_mfma_f32_16x16x32_bf16 v[116:119], v[148:151], v[48:51], v[116:119]
s_waitcnt lgkmcnt(10)
v_mfma_f32_16x16x32_bf16 v[120:123], v[144:147], v[52:55], v[120:123]
v_mfma_f32_16x16x32_bf16 v[124:127], v[148:151], v[52:55], v[124:127]
s_waitcnt lgkmcnt(7)
v_mfma_f32_16x16x32_bf16 v[96:99], v[152:155], v[56:59], v[96:99]
s_waitcnt lgkmcnt(6)
v_mfma_f32_16x16x32_bf16 v[100:103], v[156:159], v[56:59], v[100:103]
s_waitcnt lgkmcnt(4)
v_mfma_f32_16x16x32_bf16 v[104:107], v[152:155], v[60:63], v[104:107]
v_mfma_f32_16x16x32_bf16 v[108:111], v[156:159], v[60:63], v[108:111]
s_waitcnt lgkmcnt(2)
v_mfma_f32_16x16x32_bf16 v[112:115], v[152:155], v[64:67], v[112:115]
v_mfma_f32_16x16x32_bf16 v[116:119], v[156:159], v[64:67], v[116:119]
s_waitcnt lgkmcnt(0)
v_mfma_f32_16x16x32_bf16 v[120:123], v[152:155], v[68:71], v[120:123]
v_mfma_f32_16x16x32_bf16 v[124:127], v[156:159], v[68:71], v[124:127]
s_waitcnt vmcnt(4)
s_barrier
v_xor_b32 v7, 65536, v7
v_xor_b32 v8, 65536, v8
v_xor_b32 v9, 65536, v9
v_xor_b32 v10, 65536, v10
s_lshr_b32 s53, s2, 3
s_and_b32 s53, s53, 7
s_cmp_lg_u32 s53, 0
s_cbranch_scc1 Ltc4z
s_sub_u32 s53, s2, 0
s_and_b32 s53, s53, 255
s_cmp_ge_u32 s53, 256
s_cbranch_scc1 Ltc4z
s_cmp_ge_u32 s40, 1
s_cbranch_scc1 Ltc4w0
s_mul_i32 s54, s53, 1
s_add_u32 s54, s54, s40
s_mul_i32 s54, s54, 7168
s_add_u32 s54, s54, 4096
v_cmp_gt_u32 vcc, 56, v1
v_lshlrev_b32 v31, 7, v1
v_mov_b32 v32, 2147483648
v_cndmask_b32 v31, v32, v31, vcc
buffer_load_dword v0, v31, s[20:23], s54 offen
Ltc4w0:
s_cmp_lg_u32 s40, 1
s_cbranch_scc1 Ltc4w1
s_mul_i32 s54, s53, 2048
s_add_u32 s54, s54, 4096
v_cmp_gt_u32 vcc, 16, v1
v_lshlrev_b32 v31, 7, v1
v_mov_b32 v32, 2147483648
v_cndmask_b32 v31, v32, v31, vcc
buffer_load_dword v0, v31, s[16:19], s54 offen
Ltc4w1:
Ltc4z:
ds_read_b128 v[160:163], v7 offset:0
ds_read_b64_tr_b16 v[40:41], v9 offset:2048
ds_read_b64_tr_b16 v[42:43], v9 offset:10240
ds_read_b128 v[164:167], v7 offset:4096
ds_read_b64_tr_b16 v[44:45], v10 offset:2048
ds_read_b64_tr_b16 v[46:47], v10 offset:10240
ds_read_b64_tr_b16 v[48:49], v9 offset:3072
ds_read_b64_tr_b16 v[50:51], v9 offset:11264
ds_read_b64_tr_b16 v[52:53], v10 offset:3072
ds_read_b64_tr_b16 v[54:55], v10 offset:11264
s_lshr_b32 s53, s2, 3
s_and_b32 s53, s53, 7
s_cmp_lg_u32 s53, 1
s_cbranch_scc1 Ltc5z
s_sub_u32 s53, s2, 0
s_and_b32 s53, s53, 255
s_cmp_ge_u32 s53, 256
s_cbranch_scc1 Ltc5z
s_cmp_ge_u32 s40, 1
s_cbranch_scc1 Ltc5w0
s_mul_i32 s54, s53, 1
s_add_u32 s54, s54, s40
s_mul_i32 s54, s54, 7168
s_add_u32 s54, s54, 4096
v_cmp_gt_u32 vcc, 56, v1
v_lshlrev_b32 v31, 7, v1
v_mov_b32 v32, 2147483648
v_cndmask_b32 v31, v32, v31, vcc
buffer_load_dword v0, v31, s[20:23], s54 offen
Ltc5w0:
s_cmp_lg_u32 s40, 1
s_cbranch_scc1 Ltc5w1
s_mul_i32 s54, s53, 2048
s_add_u32 s54, s54, 4096
v_cmp_gt_u32 vcc, 16, v1
v_lshlrev_b32 v31, 7, v1
v_mov_b32 v32, 2147483648
v_cndmask_b32 v31, v32, v31, vcc
buffer_load_dword v0, v31, s[16:19], s54 offen
Ltc5w1:
Ltc5z:
s_waitcnt lgkmcnt(7)
v_mfma_f32_16x16x32_bf16 v[96:99], v[160:163], v[40:43], v[96:99]
ds_read_b128 v[168:171], v8 offset:0
ds_read_b64_tr_b16 v[56:57], v9 offset:18432
s_add_u32 m0, s48, 0
s_bfe_u32 s52, s47, 262160
s_add_u32 s52, s52, s89
s_and_b32 s52, s52, 7
s_lshl_b32 s93, s52, 7
s_add_u32 s93, s93, s49
buffer_load_dwordx4 v2, s[4:7], s93 offen offset:0 lds
s_waitcnt lgkmcnt(8)
v_mfma_f32_16x16x32_bf16 v[100:103], v[164:167], v[40:43], v[100:103]
ds_read_b64_tr_b16 v[58:59], v9 offset:26624
ds_read_b128 v[172:175], v8 offset:4096
s_mul_i32 s94, s52, s3
s_add_u32 s94, s94, s50
buffer_load_dwordx4 v4, s[8:11], s94 offen offset:2048 lds
s_waitcnt lgkmcnt(8)
v_mfma_f32_16x16x32_bf16 v[104:107], v[160:163], v[44:47], v[104:107]
ds_read_b64_tr_b16 v[60:61], v10 offset:18432
ds_read_b64_tr_b16 v[62:63], v10 offset:26624
buffer_load_dwordx4 v3, s[4:7], s93 offen offset:1024 lds
v_mfma_f32_16x16x32_bf16 v[108:111], v[164:167], v[44:47], v[108:111]
ds_read_b64_tr_b16 v[64:65], v9 offset:19456
ds_read_b64_tr_b16 v[66:67], v9 offset:27648
buffer_load_dwordx4 v5, s[8:11], s94 offen offset:3072 lds
s_waitcnt lgkmcnt(10)
v_mfma_f32_16x16x32_bf16 v[112:115], v[160:163], v[48:51], v[112:115]
ds_read_b64_tr_b16 v[68:69], v10 offset:19456
ds_read_b64_tr_b16 v[70:71], v10 offset:27648
s_add_u32 m0, s48, 32768
s_bfe_u32 s52, s47, 262164
s_add_u32 s52, s52, s89
s_and_b32 s52, s52, 7
s_lshl_b32 s93, s52, 7
s_add_u32 s93, s93, s49
buffer_load_dwordx4 v2, s[4:7], s93 offen offset:0 lds
v_mfma_f32_16x16x32_bf16 v[116:119], v[164:167], v[48:51], v[116:119]
s_mul_i32 s94, s52, s3
s_add_u32 s94, s94, s50
buffer_load_dwordx4 v4, s[8:11], s94 offen offset:2048 lds
s_waitcnt lgkmcnt(10)
v_mfma_f32_16x16x32_bf16 v[120:123], v[160:163], v[52:55], v[120:123]
buffer_load_dwordx4 v3, s[4:7], s93 offen offset:1024 lds
v_mfma_f32_16x16x32_bf16 v[124:127], v[164:167], v[52:55], v[124:127]
buffer_load_dwordx4 v5, s[8:11], s94 offen offset:3072 lds
s_waitcnt lgkmcnt(7)
v_mfma_f32_16x16x32_bf16 v[96:99], v[168:171], v[56:59], v[96:99]
s_waitcnt lgkmcnt(6)
v_mfma_f32_16x16x32_bf16 v[100:103], v[172:175], v[56:59], v[100:103]
s_waitcnt lgkmcnt(4)
v_mfma_f32_16x16x32_bf16 v[104:107], v[168:171], v[60:63], v[104:107]
v_mfma_f32_16x16x32_bf16 v[108:111], v[172:175], v[60:63], v[108:111]
s_waitcnt lgkmcnt(2)
v_mfma_f32_16x16x32_bf16 v[112:115], v[168:171], v[64:67], v[112:115]
v_mfma_f32_16x16x32_bf16 v[116:119], v[172:175], v[64:67], v[116:119]
s_waitcnt lgkmcnt(0)
v_mfma_f32_16x16x32_bf16 v[120:123], v[168:171], v[68:71], v[120:123]
v_mfma_f32_16x16x32_bf16 v[124:127], v[172:175], v[68:71], v[124:127]
s_waitcnt vmcnt(8)
s_barrier
s_lshr_b32 s53, s2, 3
s_and_b32 s53, s53, 7
s_cmp_lg_u32 s53, 2
s_cbranch_scc1 Ltc6z
s_sub_u32 s53, s2, 0
s_and_b32 s53, s53, 255
s_cmp_ge_u32 s53, 256
s_cbranch_scc1 Ltc6z
s_cmp_ge_u32 s40, 1
s_cbranch_scc1 Ltc6w0
s_mul_i32 s54, s53, 1
s_add_u32 s54, s54, s40
s_mul_i32 s54, s54, 7168
s_add_u32 s54, s54, 4096
v_cmp_gt_u32 vcc, 56, v1
v_lshlrev_b32 v31, 7, v1
v_mov_b32 v32, 2147483648
v_cndmask_b32 v31, v32, v31, vcc
buffer_load_dword v0, v31, s[20:23], s54 offen
Ltc6w0:
s_cmp_lg_u32 s40, 1
s_cbranch_scc1 Ltc6w1
s_mul_i32 s54, s53, 2048
s_add_u32 s54, s54, 4096
v_cmp_gt_u32 vcc, 16, v1
v_lshlrev_b32 v31, 7, v1
v_mov_b32 v32, 2147483648
v_cndmask_b32 v31, v32, v31, vcc
buffer_load_dword v0, v31, s[16:19], s54 offen
Ltc6w1:
Ltc6z:
ds_read_b128 v[176:179], v7 offset:32768
ds_read_b64_tr_b16 v[40:41], v9 offset:34816
ds_read_b64_tr_b16 v[42:43], v9 offset:43008
ds_read_b128 v[180:183], v7 offset:36864
ds_read_b64_tr_b16 v[44:45], v10 offset:34816
ds_read_b64_tr_b16 v[46:47], v10 offset:43008
ds_read_b64_tr_b16 v[48:49], v9 offset:35840
ds_read_b64_tr_b16 v[50:51], v9 offset:44032
ds_read_b64_tr_b16 v[52:53], v10 offset:35840
ds_read_b64_tr_b16 v[54:55], v10 offset:44032
s_lshr_b32 s53, s2, 3
s_and_b32 s53, s53, 7
s_cmp_lg_u32 s53, 3
s_cbranch_scc1 Ltc7z
s_sub_u32 s53, s2, 0
s_and_b32 s53, s53, 255
s_cmp_ge_u32 s53, 256
s_cbranch_scc1 Ltc7z
s_cmp_ge_u32 s40, 1
s_cbranch_scc1 Ltc7w0
s_mul_i32 s54, s53, 1
s_add_u32 s54, s54, s40
s_mul_i32 s54, s54, 7168
s_add_u32 s54, s54, 4096
v_cmp_gt_u32 vcc, 56, v1
v_lshlrev_b32 v31, 7, v1
v_mov_b32 v32, 2147483648
v_cndmask_b32 v31, v32, v31, vcc
buffer_load_dword v0, v31, s[20:23], s54 offen
Ltc7w0:
s_cmp_lg_u32 s40, 1
s_cbranch_scc1 Ltc7w1
s_mul_i32 s54, s53, 2048
s_add_u32 s54, s54, 4096
v_cmp_gt_u32 vcc, 16, v1
v_lshlrev_b32 v31, 7, v1
v_mov_b32 v32, 2147483648
v_cndmask_b32 v31, v32, v31, vcc
buffer_load_dword v0, v31, s[16:19], s54 offen
Ltc7w1:
Ltc7z:
s_waitcnt lgkmcnt(7)
v_mfma_f32_16x16x32_bf16 v[96:99], v[176:179], v[40:43], v[96:99]
ds_read_b128 v[184:187], v8 offset:32768
ds_read_b64_tr_b16 v[56:57], v9 offset:51200
s_add_u32 m0, s48, 65536
s_bfe_u32 s52, s47, 262168
s_add_u32 s52, s52, s89
s_and_b32 s52, s52, 7
s_lshl_b32 s93, s52, 7
s_add_u32 s93, s93, s49
buffer_load_dwordx4 v2, s[4:7], s93 offen offset:0 lds
s_waitcnt lgkmcnt(8)
v_mfma_f32_16x16x32_bf16 v[100:103], v[180:183], v[40:43], v[100:103]
ds_read_b64_tr_b16 v[58:59], v9 offset:59392
ds_read_b128 v[188:191], v8 offset:36864
s_waitcnt lgkmcnt(8)
v_mfma_f32_16x16x32_bf16 v[104:107], v[176:179], v[44:47], v[104:107]
ds_read_b64_tr_b16 v[60:61], v10 offset:51200
ds_read_b64_tr_b16 v[62:63], v10 offset:59392
s_mul_i32 s94, s52, s3
s_add_u32 s94, s94, s50
buffer_load_dwordx4 v4, s[8:11], s94 offen offset:2048 lds
v_mfma_f32_16x16x32_bf16 v[108:111], v[180:183], v[44:47], v[108:111]
ds_read_b64_tr_b16 v[64:65], v9 offset:52224
ds_read_b64_tr_b16 v[66:67], v9 offset:60416
s_waitcnt lgkmcnt(10)
v_mfma_f32_16x16x32_bf16 v[112:115], v[176:179], v[48:51], v[112:115]
ds_read_b64_tr_b16 v[68:69], v10 offset:52224
ds_read_b64_tr_b16 v[70:71], v10 offset:60416
buffer_load_dwordx4 v3, s[4:7], s93 offen offset:1024 lds
v_mfma_f32_16x16x32_bf16 v[116:119], v[180:183], v[48:51], v[116:119]
s_waitcnt lgkmcnt(10)
v_mfma_f32_16x16x32_bf16 v[120:123], v[176:179], v[52:55], v[120:123]
buffer_load_dwordx4 v5, s[8:11], s94 offen offset:3072 lds
v_mfma_f32_16x16x32_bf16 v[124:127], v[180:183], v[52:55], v[124:127]
s_waitcnt vmcnt(8) lgkmcnt(0)
s_barrier
v_xor_b32 v7, 65536, v7
v_xor_b32 v8, 65536, v8
v_xor_b32 v9, 65536, v9
v_xor_b32 v10, 65536, v10
s_sub_u32 s95, s60, s97
s_and_b32 s95, s95, 3
s_mov_b32 s70, 3703190032
s_mov_b32 s72, 9991764
s_mov_b32 s71, 12816
s_cmp_eq_u32 s95, 0
s_cselect_b32 s70, 3703181362, s70
s_cselect_b32 s72, 9983094, s72
s_cmp_eq_u32 s95, 1
s_cselect_b32 s70, 3694311952, s70
s_cselect_b32 s72, 7772244, s72
s_cmp_eq_u32 s95, 2
s_cselect_b32 s70, 3134992912, s70
s_cmp_eq_u32 s95, 3
s_cselect_b32 s71, 4146, s71
s_mul_i32 s96, s41, 14336
s_add_u32 s74, s62, s96
s_add_u32 s74, s74, 16384
s_lshl_b32 s95, s41, 12
s_add_u32 s75, s62, s95
s_lshl_b32 s96, s96, 5
s_add_u32 s76, s63, s96
s_lshl_b32 s95, s95, 5
s_lshr_b32 s53, s2, 3
s_and_b32 s53, s53, 7
s_cmp_lg_u32 s53, 4
s_cbranch_scc1 Ltc8z
s_sub_u32 s53, s2, 0
s_and_b32 s53, s53, 255
s_cmp_ge_u32 s53, 256
s_cbranch_scc1 Ltc8z
s_cmp_ge_u32 s40, 1
s_cbranch_scc1 Ltc8w0
s_mul_i32 s54, s53, 1
s_add_u32 s54, s54, s40
s_mul_i32 s54, s54, 7168
s_add_u32 s54, s54, 4096
v_cmp_gt_u32 vcc, 56, v1
v_lshlrev_b32 v31, 7, v1
v_mov_b32 v32, 2147483648
v_cndmask_b32 v31, v32, v31, vcc
buffer_load_dword v0, v31, s[20:23], s54 offen
Ltc8w0:
s_cmp_lg_u32 s40, 1
s_cbranch_scc1 Ltc8w1
s_mul_i32 s54, s53, 2048
s_add_u32 s54, s54, 4096
v_cmp_gt_u32 vcc, 16, v1
v_lshlrev_b32 v31, 7, v1
v_mov_b32 v32, 2147483648
v_cndmask_b32 v31, v32, v31, vcc
buffer_load_dword v0, v31, s[16:19], s54 offen
Ltc8w1:
Ltc8z:
v_mfma_f32_16x16x32_bf16 v[96:99], v[184:187], v[56:59], v[96:99]
ds_read_b128 v[192:195], v7 offset:0
ds_read_b64_tr_b16 v[40:41], v9 offset:2048
s_add_u32 m0, s48, 98304
s_bfe_u32 s52, s47, 262172
s_add_u32 s52, s52, s89
s_and_b32 s52, s52, 7
s_lshl_b32 s93, s52, 7
s_add_u32 s93, s93, s49
buffer_load_dwordx4 v2, s[4:7], s93 offen offset:0 lds
v_mfma_f32_16x16x32_bf16 v[100:103], v[188:191], v[56:59], v[100:103]
ds_read_b64_tr_b16 v[42:43], v9 offset:10240
ds_read_b128 v[196:199], v7 offset:4096
v_mfma_f32_16x16x32_bf16 v[104:107], v[184:187], v[60:63], v[104:107]
ds_read_b64_tr_b16 v[44:45], v10 offset:2048
ds_read_b64_tr_b16 v[46:47], v10 offset:10240
v_mfma_f32_16x16x32_bf16 v[108:111], v[188:191], v[60:63], v[108:111]
ds_read_b64_tr_b16 v[48:49], v9 offset:3072
ds_read_b64_tr_b16 v[50:51], v9 offset:11264
v_mfma_f32_16x16x32_bf16 v[112:115], v[184:187], v[64:67], v[112:115]
ds_read_b64_tr_b16 v[52:53], v10 offset:3072
ds_read_b64_tr_b16 v[54:55], v10 offset:11264
s_mul_i32 s94, s52, s3
s_add_u32 s94, s94, s50
buffer_load_dwordx4 v4, s[8:11], s94 offen offset:2048 lds
v_mfma_f32_16x16x32_bf16 v[116:119], v[188:191], v[64:67], v[116:119]
v_mfma_f32_16x16x32_bf16 v[120:123], v[184:187], v[68:71], v[120:123]
v_mfma_f32_16x16x32_bf16 v[124:127], v[188:191], v[68:71], v[124:127]
s_lshr_b32 s53, s2, 3
s_and_b32 s53, s53, 7
s_cmp_lg_u32 s53, 5
s_cbranch_scc1 Ltc9z
s_sub_u32 s53, s2, 0
s_and_b32 s53, s53, 255
s_cmp_ge_u32 s53, 256
s_cbranch_scc1 Ltc9z
s_cmp_ge_u32 s40, 1
s_cbranch_scc1 Ltc9w0
s_mul_i32 s54, s53, 1
s_add_u32 s54, s54, s40
s_mul_i32 s54, s54, 7168
s_add_u32 s54, s54, 4096
v_cmp_gt_u32 vcc, 56, v1
v_lshlrev_b32 v31, 7, v1
v_mov_b32 v32, 2147483648
v_cndmask_b32 v31, v32, v31, vcc
buffer_load_dword v0, v31, s[20:23], s54 offen
Ltc9w0:
s_cmp_lg_u32 s40, 1
s_cbranch_scc1 Ltc9w1
s_mul_i32 s54, s53, 2048
s_add_u32 s54, s54, 4096
v_cmp_gt_u32 vcc, 16, v1
v_lshlrev_b32 v31, 7, v1
v_mov_b32 v32, 2147483648
v_cndmask_b32 v31, v32, v31, vcc
buffer_load_dword v0, v31, s[16:19], s54 offen
Ltc9w1:
Ltc9z:
s_waitcnt lgkmcnt(7)
v_mfma_f32_16x16x32_bf16 v[96:99], v[192:195], v[40:43], v[96:99]
ds_read_b128 v[200:203], v8 offset:0
ds_read_b64_tr_b16 v[56:57], v9 offset:18432
buffer_load_dwordx4 v3, s[4:7], s93 offen offset:1024 lds
s_waitcnt lgkmcnt(8)
v_mfma_f32_16x16x32_bf16 v[100:103], v[196:199], v[40:43], v[100:103]
ds_read_b64_tr_b16 v[58:59], v9 offset:26624
ds_read_b128 v[204:207], v8 offset:4096
s_waitcnt lgkmcnt(8)
v_mfma_f32_16x16x32_bf16 v[104:107], v[192:195], v[44:47], v[104:107]
ds_read_b64_tr_b16 v[60:61], v10 offset:18432
ds_read_b64_tr_b16 v[62:63], v10 offset:26624
buffer_load_dwordx4 v5, s[8:11], s94 offen offset:3072 lds
v_mfma_f32_16x16x32_bf16 v[108:111], v[196:199], v[44:47], v[108:111]
ds_read_b64_tr_b16 v[64:65], v9 offset:19456
ds_read_b64_tr_b16 v[66:67], v9 offset:27648
s_waitcnt lgkmcnt(10)
v_mfma_f32_16x16x32_bf16 v[112:115], v[192:195], v[48:51], v[112:115]
ds_read_b64_tr_b16 v[68:69], v10 offset:19456
ds_read_b64_tr_b16 v[70:71], v10 offset:27648
v_mfma_f32_16x16x32_bf16 v[116:119], v[196:199], v[48:51], v[116:119]
buffer_load_dwordx4 v[88:91], v15, s[4:7], s78 offen
buffer_load_dwordx4 v[92:95], v15, s[36:39], 0 offen
s_waitcnt lgkmcnt(10)
v_mfma_f32_16x16x32_bf16 v[120:123], v[192:195], v[52:55], v[120:123]
v_mfma_f32_16x16x32_bf16 v[124:127], v[196:199], v[52:55], v[124:127]
s_waitcnt vmcnt(10) lgkmcnt(0)
s_barrier
s_add_u32 s77, s63, s95
s_lshl3_add_u32 s95, s42, s41
s_lshl_b32 s96, s95, 6
s_lshl_b32 s95, s95, 10
s_add_u32 s83, s95, 131072
s_add_u32 s96, s96, 147456
v_add_u32 v13, s96, v1
v_and_b32 v23, 15, v1
v_cmp_eq_u32 vcc, 0, v23
v_add_u32 v24, 151552, v15
s_nop 0
v_cndmask_b32 v13, v24, v13, vcc
v_and_b32 v11, 48, v1
v_lshlrev_b32 v11, 4, v11
v_lshl_add_u32 v11, v23, 2, v11
v_add_u32 v11, 147456, v11
s_lshr_b32 s95, s40, 1
s_lshl_b32 s95, s95, 12
s_and_b32 s96, s40, 1
s_lshl3_add_u32 s95, s96, s95
s_add_u32 s84, s95, 131072
v_lshl_add_u32 v4, v33, 9, v4
v_subrev_u32 v4, 1024, v4
s_lshr_b32 s53, s2, 3
s_and_b32 s53, s53, 7
s_cmp_lg_u32 s53, 6
s_cbranch_scc1 Ltc10z
s_sub_u32 s53, s2, 0
s_and_b32 s53, s53, 255
s_cmp_ge_u32 s53, 256
s_cbranch_scc1 Ltc10z
s_cmp_ge_u32 s40, 1
s_cbranch_scc1 Ltc10w0
s_mul_i32 s54, s53, 1
s_add_u32 s54, s54, s40
s_mul_i32 s54, s54, 7168
s_add_u32 s54, s54, 4096
v_cmp_gt_u32 vcc, 56, v1
v_lshlrev_b32 v31, 7, v1
v_mov_b32 v32, 2147483648
v_cndmask_b32 v31, v32, v31, vcc
buffer_load_dword v0, v31, s[20:23], s54 offen
Ltc10w0:
s_cmp_lg_u32 s40, 1
s_cbranch_scc1 Ltc10w1
s_mul_i32 s54, s53, 2048
s_add_u32 s54, s54, 4096
v_cmp_gt_u32 vcc, 16, v1
v_lshlrev_b32 v31, 7, v1
v_mov_b32 v32, 2147483648
v_cndmask_b32 v31, v32, v31, vcc
buffer_load_dword v0, v31, s[16:19], s54 offen
Ltc10w1:
Ltc10z:
v_mfma_f32_16x16x32_bf16 v[96:99], v[200:203], v[56:59], v[96:99]
ds_read_b128 v[208:211], v7 offset:32768
ds_read_b64_tr_b16 v[40:41], v9 offset:34816
s_add_u32 m0, s48, 0
s_bfe_u32 s52, s47, 262144
s_add_u32 s52, s52, s89
s_and_b32 s52, s52, 7
s_mul_i32 s94, s52, 229376
s_add_u32 s94, s94, s51
buffer_load_dwordx4 v4, s[12:15], s94 offen offset:0 lds
v_mfma_f32_16x16x32_bf16 v[100:103], v[204:207], v[56:59], v[100:103]
ds_read_b64_tr_b16 v[42:43], v9 offset:43008
ds_read_b128 v[212:215], v7 offset:36864
v_mfma_f32_16x16x32_bf16 v[104:107], v[200:203], v[60:63], v[104:107]
ds_read_b64_tr_b16 v[44:45], v10 offset:34816
ds_read_b64_tr_b16 v[46:47], v10 offset:43008
v_mfma_f32_16x16x32_bf16 v[108:111], v[204:207], v[60:63], v[108:111]
ds_read_b64_tr_b16 v[48:49], v9 offset:35840
ds_read_b64_tr_b16 v[50:51], v9 offset:44032
v_mfma_f32_16x16x32_bf16 v[112:115], v[200:203], v[64:67], v[112:115]
ds_read_b64_tr_b16 v[52:53], v10 offset:35840
ds_read_b64_tr_b16 v[54:55], v10 offset:44032
s_bfe_u32 s52, s47, 262148
s_add_u32 s52, s52, s89
s_and_b32 s52, s52, 7
s_mul_i32 s94, s52, 229376
s_add_u32 s94, s94, s51
s_sub_u32 s94, s94, 1024
buffer_load_dwordx4 v4, s[12:15], s94 offen offset:1024 lds
v_mfma_f32_16x16x32_bf16 v[116:119], v[204:207], v[64:67], v[116:119]
v_mfma_f32_16x16x32_bf16 v[120:123], v[200:203], v[68:71], v[120:123]
v_mfma_f32_16x16x32_bf16 v[124:127], v[204:207], v[68:71], v[124:127]
s_lshr_b32 s53, s2, 3
s_and_b32 s53, s53, 7
s_cmp_lg_u32 s53, 7
s_cbranch_scc1 Ltc11z
s_sub_u32 s53, s2, 0
s_and_b32 s53, s53, 255
s_cmp_ge_u32 s53, 256
s_cbranch_scc1 Ltc11z
s_cmp_ge_u32 s40, 1
s_cbranch_scc1 Ltc11w0
s_mul_i32 s54, s53, 1
s_add_u32 s54, s54, s40
s_mul_i32 s54, s54, 7168
s_add_u32 s54, s54, 4096
v_cmp_gt_u32 vcc, 56, v1
v_lshlrev_b32 v31, 7, v1
v_mov_b32 v32, 2147483648
v_cndmask_b32 v31, v32, v31, vcc
buffer_load_dword v0, v31, s[20:23], s54 offen
Ltc11w0:
s_cmp_lg_u32 s40, 1
s_cbranch_scc1 Ltc11w1
s_mul_i32 s54, s53, 2048
s_add_u32 s54, s54, 4096
v_cmp_gt_u32 vcc, 16, v1
v_lshlrev_b32 v31, 7, v1
v_mov_b32 v32, 2147483648
v_cndmask_b32 v31, v32, v31, vcc
buffer_load_dword v0, v31, s[16:19], s54 offen
Ltc11w1:
Ltc11z:
s_waitcnt lgkmcnt(7)
v_mfma_f32_16x16x32_bf16 v[96:99], v[208:211], v[40:43], v[96:99]
ds_read_b128 v[216:219], v8 offset:32768
ds_read_b64_tr_b16 v[56:57], v9 offset:51200
s_bfe_u32 s52, s47, 262152
s_add_u32 s52, s52, s89
s_and_b32 s52, s52, 7
s_mul_i32 s94, s52, 229376
s_add_u32 s94, s94, s51
s_sub_u32 s94, s94, 2048
buffer_load_dwordx4 v4, s[12:15], s94 offen offset:2048 lds
s_waitcnt lgkmcnt(8)
v_mfma_f32_16x16x32_bf16 v[100:103], v[212:215], v[40:43], v[100:103]
ds_read_b64_tr_b16 v[58:59], v9 offset:59392
ds_read_b128 v[220:223], v8 offset:36864
s_waitcnt lgkmcnt(8)
v_mfma_f32_16x16x32_bf16 v[104:107], v[208:211], v[44:47], v[104:107]
ds_read_b64_tr_b16 v[60:61], v10 offset:51200
ds_read_b64_tr_b16 v[62:63], v10 offset:59392
v_mfma_f32_16x16x32_bf16 v[108:111], v[212:215], v[44:47], v[108:111]
ds_read_b64_tr_b16 v[64:65], v9 offset:52224
ds_read_b64_tr_b16 v[66:67], v9 offset:60416
s_waitcnt lgkmcnt(10)
v_mfma_f32_16x16x32_bf16 v[112:115], v[208:211], v[48:51], v[112:115]
ds_read_b64_tr_b16 v[68:69], v10 offset:52224
ds_read_b64_tr_b16 v[70:71], v10 offset:60416
s_bfe_u32 s52, s47, 262156
s_add_u32 s52, s52, s89
s_and_b32 s52, s52, 7
s_mul_i32 s94, s52, 229376
s_add_u32 s94, s94, s51
s_sub_u32 s94, s94, 3072
buffer_load_dwordx4 v4, s[12:15], s94 offen offset:3072 lds
v_mfma_f32_16x16x32_bf16 v[116:119], v[212:215], v[48:51], v[116:119]
s_waitcnt lgkmcnt(10)
v_mfma_f32_16x16x32_bf16 v[120:123], v[208:211], v[52:55], v[120:123]
v_mfma_f32_16x16x32_bf16 v[124:127], v[212:215], v[52:55], v[124:127]
s_waitcnt vmcnt(10) lgkmcnt(0)
s_barrier
v_xor_b32 v7, 65536, v7
v_xor_b32 v8, 65536, v8
v_xor_b32 v9, 65536, v9
v_xor_b32 v10, 65536, v10
s_lshl3_add_u32 s95, s46, s40
s_lshr_b32 s96, s43, 2
s_lshl2_add_u32 s95, s95, s96
s_lshl_b32 s95, s95, 8
s_and_b32 s97, s43, 3
s_add_u32 s95, s95, s97
s_lshl2_add_u32 s85, s95, 131072
s_lshl4_add_u32 s96, s46, s96
s_lshl_b32 s96, s96, 6
s_add_u32 s96, s96, s97
s_lshl2_add_u32 s86, s96, 65536
s_cmp_eq_u32 s40, 0
s_cselect_b32 s86, s86, 1879048192
s_mul_i32 s95, s45, 448
s_lshl2_add_u32 s96, s44, s42
s_lshl_b32 s96, s96, 5
s_add_u32 s95, s95, s96
s_add_u32 s95, s95, 512
s_lshl_b32 s95, s95, 5
s_add_u32 s87, s95, s57
v_mfma_f32_16x16x32_bf16 v[96:99], v[216:219], v[56:59], v[96:99]
ds_read_b128 v[224:227], v7 offset:0
ds_read_b64_tr_b16 v[40:41], v9 offset:2048
s_add_u32 m0, s48, 32768
s_bfe_u32 s52, s47, 262160
s_add_u32 s52, s52, s89
s_and_b32 s52, s52, 7
s_mul_i32 s94, s52, 229376
s_add_u32 s94, s94, s51
buffer_load_dwordx4 v4, s[12:15], s94 offen offset:0 lds
v_mfma_f32_16x16x32_bf16 v[100:103], v[220:223], v[56:59], v[100:103]
ds_read_b64_tr_b16 v[42:43], v9 offset:10240
ds_read_b128 v[228:231], v7 offset:4096
v_mfma_f32_16x16x32_bf16 v[104:107], v[216:219], v[60:63], v[104:107]
ds_read_b64_tr_b16 v[44:45], v10 offset:2048
ds_read_b64_tr_b16 v[46:47], v10 offset:10240
v_mfma_f32_16x16x32_bf16 v[108:111], v[220:223], v[60:63], v[108:111]
ds_read_b64_tr_b16 v[48:49], v9 offset:3072
ds_read_b64_tr_b16 v[50:51], v9 offset:11264
v_mfma_f32_16x16x32_bf16 v[112:115], v[216:219], v[64:67], v[112:115]
ds_read_b64_tr_b16 v[52:53], v10 offset:3072
ds_read_b64_tr_b16 v[54:55], v10 offset:11264
s_bfe_u32 s52, s47, 262164
s_add_u32 s52, s52, s89
s_and_b32 s52, s52, 7
s_mul_i32 s94, s52, 229376
s_add_u32 s94, s94, s51
s_sub_u32 s94, s94, 1024
buffer_load_dwordx4 v4, s[12:15], s94 offen offset:1024 lds
v_mfma_f32_16x16x32_bf16 v[116:119], v[220:223], v[64:67], v[116:119]
v_mfma_f32_16x16x32_bf16 v[120:123], v[216:219], v[68:71], v[120:123]
v_mfma_f32_16x16x32_bf16 v[124:127], v[220:223], v[68:71], v[124:127]
v_mov_b32 v35, 0
buffer_load_dword v34, v35, s[32:35], 0 offen sc1
s_waitcnt lgkmcnt(7)
v_mfma_f32_16x16x32_bf16 v[96:99], v[224:227], v[40:43], v[96:99]
ds_read_b128 v[232:235], v8 offset:0
ds_read_b64_tr_b16 v[56:57], v9 offset:18432
s_bfe_u32 s52, s47, 262168
s_add_u32 s52, s52, s89
s_and_b32 s52, s52, 7
s_mul_i32 s94, s52, 229376
s_add_u32 s94, s94, s51
s_sub_u32 s94, s94, 2048
buffer_load_dwordx4 v4, s[12:15], s94 offen offset:2048 lds
s_waitcnt lgkmcnt(8)
v_mfma_f32_16x16x32_bf16 v[100:103], v[228:231], v[40:43], v[100:103]
ds_read_b64_tr_b16 v[58:59], v9 offset:26624
ds_read_b128 v[236:239], v8 offset:4096
s_waitcnt lgkmcnt(8)
v_mfma_f32_16x16x32_bf16 v[104:107], v[224:227], v[44:47], v[104:107]
ds_read_b64_tr_b16 v[60:61], v10 offset:18432
ds_read_b64_tr_b16 v[62:63], v10 offset:26624
v_mfma_f32_16x16x32_bf16 v[108:111], v[228:231], v[44:47], v[108:111]
ds_read_b64_tr_b16 v[64:65], v9 offset:19456
ds_read_b64_tr_b16 v[66:67], v9 offset:27648
s_waitcnt lgkmcnt(10)
v_mfma_f32_16x16x32_bf16 v[112:115], v[224:227], v[48:51], v[112:115]
ds_read_b64_tr_b16 v[68:69], v10 offset:19456
ds_read_b64_tr_b16 v[70:71], v10 offset:27648
s_bfe_u32 s52, s47, 262172
s_add_u32 s52, s52, s89
s_and_b32 s52, s52, 7
s_mul_i32 s94, s52, 229376
s_add_u32 s94, s94, s51
s_sub_u32 s94, s94, 3072
buffer_load_dwordx4 v4, s[12:15], s94 offen offset:3072 lds
v_mfma_f32_16x16x32_bf16 v[116:119], v[228:231], v[48:51], v[116:119]
s_waitcnt lgkmcnt(10)
v_mfma_f32_16x16x32_bf16 v[120:123], v[224:227], v[52:55], v[120:123]
v_mfma_f32_16x16x32_bf16 v[124:127], v[228:231], v[52:55], v[124:127]
s_waitcnt vmcnt(11) lgkmcnt(0)
s_barrier
v_mfma_f32_16x16x32_bf16 v[96:99], v[232:235], v[56:59], v[96:99]
ds_read_b128 v[240:243], v7 offset:32768
ds_read_b64_tr_b16 v[40:41], v9 offset:34816
s_add_u32 m0, s48, 65536
s_bfe_u32 s94, s70, 262144
s_lshl_b32 s94, s94, 15
s_add_u32 s94, s94, s76
buffer_load_dwordx4 v16, s[20:23], s94 offen offset:0 lds
v_mfma_f32_16x16x32_bf16 v[100:103], v[236:239], v[56:59], v[100:103]
ds_read_b64_tr_b16 v[42:43], v9 offset:43008
ds_read_b128 v[244:247], v7 offset:36864
v_mfma_f32_16x16x32_bf16 v[104:107], v[232:235], v[60:63], v[104:107]
ds_read_b64_tr_b16 v[44:45], v10 offset:34816
ds_read_b64_tr_b16 v[46:47], v10 offset:43008
v_mfma_f32_16x16x32_bf16 v[108:111], v[236:239], v[60:63], v[108:111]
ds_read_b64_tr_b16 v[48:49], v9 offset:35840
ds_read_b64_tr_b16 v[50:51], v9 offset:44032
v_mfma_f32_16x16x32_bf16 v[112:115], v[232:235], v[64:67], v[112:115]
ds_read_b64_tr_b16 v[52:53], v10 offset:35840
ds_read_b64_tr_b16 v[54:55], v10 offset:44032
buffer_load_dwordx4 v17, s[20:23], s94 offen offset:1024 lds
v_mfma_f32_16x16x32_bf16 v[116:119], v[236:239], v[64:67], v[116:119]
v_mfma_f32_16x16x32_bf16 v[120:123], v[232:235], v[68:71], v[120:123]
v_mfma_f32_16x16x32_bf16 v[124:127], v[236:239], v[68:71], v[124:127]
s_waitcnt lgkmcnt(7)
v_mfma_f32_16x16x32_bf16 v[96:99], v[240:243], v[40:43], v[96:99]
ds_read_b128 v[248:251], v8 offset:32768
ds_read_b64_tr_b16 v[56:57], v9 offset:51200
s_waitcnt vmcnt(11)
v_dot2_f32_bf16 v28, v88, v92, 0
v_dot2_f32_bf16 v28, v89, v93, v28
v_dot2_f32_bf16 v28, v90, v94, v28
v_dot2_f32_bf16 v28, v91, v95, v28
s_nop 2
v_add_f32_dpp v28, v28, v28 row_ror:1 row_mask:0xf bank_mask:0xf
s_waitcnt lgkmcnt(8)
v_mfma_f32_16x16x32_bf16 v[100:103], v[244:247], v[40:43], v[100:103]
ds_read_b64_tr_b16 v[58:59], v9 offset:59392
ds_read_b128 v[252:255], v8 offset:36864
v_add_f32_dpp v28, v28, v28 row_ror:2 row_mask:0xf bank_mask:0xf
s_nop 1
v_add_f32_dpp v28, v28, v28 row_ror:4 row_mask:0xf bank_mask:0xf
s_waitcnt lgkmcnt(8)
v_mfma_f32_16x16x32_bf16 v[104:107], v[240:243], v[44:47], v[104:107]
ds_read_b64_tr_b16 v[60:61], v10 offset:51200
ds_read_b64_tr_b16 v[62:63], v10 offset:59392
v_add_f32_dpp v28, v28, v28 row_ror:8 row_mask:0xf bank_mask:0xf
s_bfe_u32 s94, s70, 262148
s_lshl_b32 s94, s94, 15
s_add_u32 s94, s94, s76
s_sub_u32 s94, s94, 2048
buffer_load_dwordx4 v16, s[20:23], s94 offen offset:2048 lds
v_mfma_f32_16x16x32_bf16 v[108:111], v[244:247], v[44:47], v[108:111]
ds_read_b64_tr_b16 v[64:65], v9 offset:52224
ds_read_b64_tr_b16 v[66:67], v9 offset:60416
v_add_f32_dpp v28, v28, v28 row_bcast:15 row_mask:0xa bank_mask:0xf
s_nop 1
v_add_f32_dpp v28, v28, v28 row_bcast:31 row_mask:0xc bank_mask:0xf
s_waitcnt lgkmcnt(10)
v_mfma_f32_16x16x32_bf16 v[112:115], v[240:243], v[48:51], v[112:115]
ds_read_b64_tr_b16 v[68:69], v10 offset:52224
ds_read_b64_tr_b16 v[70:71], v10 offset:60416
v_mul_f32 v28, 0xbfb8aa3b, v28
v_exp_f32 v28, v28
s_nop 0
v_add_f32 v28, 1.0, v28
v_mfma_f32_16x16x32_bf16 v[116:119], v[244:247], v[48:51], v[116:119]
buffer_load_dwordx4 v17, s[20:23], s94 offen offset:3072 lds
v_rcp_f32 v28, v28
s_waitcnt lgkmcnt(10)
v_mfma_f32_16x16x32_bf16 v[120:123], v[240:243], v[52:55], v[120:123]
v_mov_b32 v30, 2147483648
v_writelane_b32 v30, 0, 63
v_mfma_f32_16x16x32_bf16 v[124:127], v[244:247], v[52:55], v[124:127]
s_lshl2_add_u32 s55, s69, 65536
buffer_store_dword v28, v30, s[24:27], s55 offen offset:0 sc1
s_waitcnt vmcnt(10) lgkmcnt(0)
s_barrier
v_xor_b32 v9, 65536, v9
v_xor_b32 v10, 65536, v10
v_mfma_f32_16x16x32_bf16 v[96:99], v[248:251], v[56:59], v[96:99]
ds_read_b64_tr_b16 v[40:41], v9 offset:0
ds_read_b64_tr_b16 v[42:43], v9 offset:8192
v_mfma_f32_16x16x32_bf16 v[100:103], v[252:255], v[56:59], v[100:103]
ds_read_b64_tr_b16 v[44:45], v10 offset:0
ds_read_b64_tr_b16 v[46:47], v10 offset:8192
v_mfma_f32_16x16x32_bf16 v[104:107], v[248:251], v[60:63], v[104:107]
ds_read_b64_tr_b16 v[48:49], v9 offset:16384
ds_read_b64_tr_b16 v[50:51], v9 offset:24576
v_mfma_f32_16x16x32_bf16 v[108:111], v[252:255], v[60:63], v[108:111]
ds_read_b64_tr_b16 v[52:53], v10 offset:16384
ds_read_b64_tr_b16 v[54:55], v10 offset:24576
v_mfma_f32_16x16x32_bf16 v[112:115], v[248:251], v[64:67], v[112:115]
v_mfma_f32_16x16x32_bf16 v[116:119], v[252:255], v[64:67], v[116:119]
v_mfma_f32_16x16x32_bf16 v[120:123], v[248:251], v[68:71], v[120:123]
v_mfma_f32_16x16x32_bf16 v[124:127], v[252:255], v[68:71], v[124:127]
s_waitcnt vmcnt(7)
v_readfirstlane_b32 s58, v34
s_nop 0
s_cmp_lg_u32 s58, 0
s_cbranch_scc1 Lnk12
s_mov_b32 s69, 0
Lns13:
buffer_load_dword v34, v35, s[32:35], 0 offen sc1
s_add_u32 s69, s69, 1
s_waitcnt vmcnt(0)
v_readfirstlane_b32 s58, v34
s_cmp_ge_u32 s69, 0x100000
s_cbranch_scc1 Lnk12
s_cmp_eq_u32 s58, 0
s_cbranch_scc1 Lns13
Lnk12:
s_waitcnt lgkmcnt(6)
v_mfma_f32_16x16x32_bf16 v[72:75], v[40:43], v[128:131], 0
ds_read_b64_tr_b16 v[56:57], v9 offset:1024
ds_read_b64_tr_b16 v[58:59], v9 offset:9216
v_mov_b32 v31, s68
v_mov_b32 v92, 0x3f803f80
v_mov_b32 v93, 0x3f803f80
v_mov_b32 v94, 0x3f803f80
v_mov_b32 v95, 0x3f803f80
v_fma_f32 v23, v96, s66, v31
v_mfma_f32_16x16x32_bf16 v[76:79], v[40:43], v[132:135], 0
ds_read_b64_tr_b16 v[60:61], v10 offset:1024
ds_read_b64_tr_b16 v[62:63], v10 offset:9216
v_fma_f32 v24, v97, s66, v31
v_fma_f32 v25, v98, s66, v31
v_fma_f32 v26, v99, s66, v31
v_exp_f32_e64 v23, v23 clamp
v_exp_f32_e64 v24, v24 clamp
v_exp_f32_e64 v25, v25 clamp
s_waitcnt lgkmcnt(8)
v_mfma_f32_16x16x32_bf16 v[80:83], v[44:47], v[128:131], 0
ds_read_b64_tr_b16 v[64:65], v9 offset:17408
ds_read_b64_tr_b16 v[66:67], v9 offset:25600
v_exp_f32_e64 v26, v26 clamp
v_max_f32 v96, s67, v96
v_max_f32 v97, s67, v97
v_max_f32 v98, s67, v98
v_max_f32 v99, s67, v99
v_add_f32 v96, v96, v23
v_mfma_f32_16x16x32_bf16 v[84:87], v[44:47], v[132:135], 0
ds_read_b64_tr_b16 v[68:69], v10 offset:17408
ds_read_b64_tr_b16 v[70:71], v10 offset:25600
v_add_f32 v97, v97, v24
v_add_f32 v98, v98, v25
v_add_f32 v99, v99, v26
v_fma_f32 v27, v100, s66, v31
v_fma_f32 v28, v101, s66, v31
v_fma_f32 v29, v102, s66, v31
s_waitcnt lgkmcnt(10)
v_mfma_f32_16x16x32_bf16 v[72:75], v[48:51], v[136:139], v[72:75]
v_fma_f32 v30, v103, s66, v31
v_exp_f32_e64 v27, v27 clamp
v_exp_f32_e64 v28, v28 clamp
v_exp_f32_e64 v29, v29 clamp
v_exp_f32_e64 v30, v30 clamp
v_max_f32 v100, s67, v100
v_mfma_f32_16x16x32_bf16 v[76:79], v[48:51], v[140:143], v[76:79]
v_max_f32 v101, s67, v101
v_max_f32 v102, s67, v102
v_max_f32 v103, s67, v103
v_add_f32 v100, v100, v27
v_add_f32 v101, v101, v28
v_add_f32 v102, v102, v29
s_waitcnt lgkmcnt(8)
v_mfma_f32_16x16x32_bf16 v[80:83], v[52:55], v[136:139], v[80:83]
v_add_f32 v103, v103, v30
v_cvt_pk_bf16_f32 v96, v96, v97
v_cvt_pk_bf16_f32 v97, v98, v99
v_cvt_pk_bf16_f32 v98, v100, v101
v_cvt_pk_bf16_f32 v99, v102, v103
v_cvt_pk_bf16_f32 v112, v112, v113
v_mfma_f32_16x16x32_bf16 v[84:87], v[52:55], v[140:143], v[84:87]
v_cvt_pk_bf16_f32 v113, v114, v115
v_cvt_pk_bf16_f32 v114, v116, v117
v_cvt_pk_bf16_f32 v115, v118, v119
s_nop 1
v_mfma_f32_16x16x32_bf16 v[100:103], v[96:99], v[112:115], 0
v_mfma_f32_16x16x32_bf16 v[116:119], v[96:99], v[92:95], 0
s_waitcnt lgkmcnt(6)
v_mfma_f32_16x16x32_bf16 v[72:75], v[56:59], v[144:147], v[72:75]
ds_read_b64_tr_b16 v[40:41], v9 offset:2048
ds_read_b64_tr_b16 v[42:43], v9 offset:10240
v_fma_f32 v23, v104, s66, v31
v_fma_f32 v24, v105, s66, v31
v_fma_f32 v25, v106, s66, v31
v_fma_f32 v26, v107, s66, v31
v_exp_f32_e64 v23, v23 clamp
v_exp_f32_e64 v24, v24 clamp
v_mfma_f32_16x16x32_bf16 v[76:79], v[56:59], v[148:151], v[76:79]
ds_read_b64_tr_b16 v[44:45], v10 offset:2048
ds_read_b64_tr_b16 v[46:47], v10 offset:10240
v_exp_f32_e64 v25, v25 clamp
v_exp_f32_e64 v26, v26 clamp
v_max_f32 v104, s67, v104
v_max_f32 v105, s67, v105
v_max_f32 v106, s67, v106
v_max_f32 v107, s67, v107
s_waitcnt lgkmcnt(8)
v_mfma_f32_16x16x32_bf16 v[80:83], v[60:63], v[144:147], v[80:83]
ds_read_b64_tr_b16 v[48:49], v9 offset:18432
ds_read_b64_tr_b16 v[50:51], v9 offset:26624
v_add_f32 v104, v104, v23
v_add_f32 v105, v105, v24
v_add_f32 v106, v106, v25
v_add_f32 v107, v107, v26
v_fma_f32 v27, v108, s66, v31
v_fma_f32 v28, v109, s66, v31
v_mfma_f32_16x16x32_bf16 v[84:87], v[60:63], v[148:151], v[84:87]
ds_read_b64_tr_b16 v[52:53], v10 offset:18432
ds_read_b64_tr_b16 v[54:55], v10 offset:26624
v_fma_f32 v29, v110, s66, v31
v_fma_f32 v30, v111, s66, v31
v_exp_f32_e64 v27, v27 clamp
v_exp_f32_e64 v28, v28 clamp
v_exp_f32_e64 v29, v29 clamp
v_exp_f32_e64 v30, v30 clamp
s_waitcnt lgkmcnt(10)
v_mfma_f32_16x16x32_bf16 v[72:75], v[64:67], v[152:155], v[72:75]
v_max_f32 v108, s67, v108
v_max_f32 v109, s67, v109
v_max_f32 v110, s67, v110
v_max_f32 v111, s67, v111
v_add_f32 v108, v108, v27
v_add_f32 v109, v109, v28
v_mfma_f32_16x16x32_bf16 v[76:79], v[64:67], v[156:159], v[76:79]
v_add_f32 v110, v110, v29
v_add_f32 v111, v111, v30
v_cvt_pk_bf16_f32 v104, v104, v105
v_cvt_pk_bf16_f32 v105, v106, v107
v_cvt_pk_bf16_f32 v106, v108, v109
v_cvt_pk_bf16_f32 v107, v110, v111
s_waitcnt lgkmcnt(8)
v_mfma_f32_16x16x32_bf16 v[80:83], v[68:71], v[152:155], v[80:83]
v_cvt_pk_bf16_f32 v120, v120, v121
v_cvt_pk_bf16_f32 v121, v122, v123
v_cvt_pk_bf16_f32 v122, v124, v125
v_cvt_pk_bf16_f32 v123, v126, v127
s_nop 1
v_mfma_f32_16x16x32_bf16 v[108:111], v[104:107], v[120:123], 0
v_mfma_f32_16x16x32_bf16 v[124:127], v[104:107], v[92:95], 0
v_mfma_f32_16x16x32_bf16 v[84:87], v[68:71], v[156:159], v[84:87]
v_add_u32 v23, s83, v15
ds_write_b128 v23, v[100:103] offset:0
ds_write_b128 v13, v[116:119] offset:0
s_nop 2
ds_write_b128 v23, v[108:111] offset:4096
ds_write_b128 v13, v[124:127] offset:256
v_add_u32 v30, s84, v15
s_waitcnt lgkmcnt(0)
s_barrier
ds_read_b64 v[88:89], v30 offset:0
ds_read_b64 v[90:91], v30 offset:1024
ds_read_b64 v[92:93], v30 offset:2048
ds_read_b64 v[94:95], v30 offset:3072
ds_read2_b32 v[24:25], v11 offset0:0 offset1:16
ds_read2_b32 v[26:27], v11 offset0:32 offset1:48
v_mfma_f32_16x16x32_bf16 v[72:75], v[40:43], v[160:163], v[72:75]
ds_read_b64_tr_b16 v[56:57], v9 offset:3072
ds_read_b64_tr_b16 v[58:59], v9 offset:11264
v_lshlrev_b32 v29, 2, v11
s_waitcnt lgkmcnt(2)
v_mfma_f32_16x16x32_bf16 v[76:79], v[40:43], v[164:167], v[76:79]
ds_read_b64_tr_b16 v[60:61], v10 offset:3072
ds_read_b64_tr_b16 v[62:63], v10 offset:11264
v_add_f32 v88, v88, v90
v_add_f32 v92, v92, v94
v_mfma_f32_16x16x32_bf16 v[80:83], v[44:47], v[160:163], v[80:83]
ds_read_b64_tr_b16 v[64:65], v9 offset:19456
ds_read_b64_tr_b16 v[66:67], v9 offset:27648
v_add_f32 v89, v89, v91
v_add_f32 v93, v93, v95
v_mfma_f32_16x16x32_bf16 v[84:87], v[44:47], v[164:167], v[84:87]
ds_read_b64_tr_b16 v[68:69], v10 offset:19456
ds_read_b64_tr_b16 v[70:71], v10 offset:27648
v_add_f32 v24, v24, v25
v_add_f32 v26, v26, v27
v_mfma_f32_16x16x32_bf16 v[72:75], v[48:51], v[168:171], v[72:75]
v_add_f32 v88, v88, v92
v_add_f32 v89, v89, v93
v_mfma_f32_16x16x32_bf16 v[76:79], v[48:51], v[172:175], v[76:79]
v_add_f32 v24, v24, v26
v_cvt_pk_bf16_f32 v88, v88, v89
v_mfma_f32_16x16x32_bf16 v[80:83], v[52:55], v[168:171], v[80:83]
v_and_b32 v25, 0xffff0000, v24
v_sub_f32 v24, v24, v25
v_mfma_f32_16x16x32_bf16 v[84:87], v[52:55], v[172:175], v[84:87]
v_cvt_pk_bf16_f32 v24, v25, v24
buffer_store_dword v88, v15, s[24:27], s85 offen sc1
buffer_store_dword v24, v29, s[24:27], s86 offen sc1
s_waitcnt vmcnt(7) lgkmcnt(0)
s_barrier
v_mfma_f32_16x16x32_bf16 v[72:75], v[56:59], v[176:179], v[72:75]
ds_read_b64_tr_b16 v[40:41], v9 offset:32768
ds_read_b64_tr_b16 v[42:43], v9 offset:40960
s_add_u32 m0, s48, 98304
s_bfe_u32 s94, s70, 262152
s_lshl_b32 s94, s94, 15
s_add_u32 s94, s94, s76
buffer_load_dwordx4 v16, s[20:23], s94 offen offset:0 lds
v_mfma_f32_16x16x32_bf16 v[76:79], v[56:59], v[180:183], v[76:79]
ds_read_b64_tr_b16 v[44:45], v10 offset:32768
ds_read_b64_tr_b16 v[46:47], v10 offset:40960
v_mfma_f32_16x16x32_bf16 v[80:83], v[60:63], v[176:179], v[80:83]
ds_read_b64_tr_b16 v[48:49], v9 offset:49152
ds_read_b64_tr_b16 v[50:51], v9 offset:57344
v_mfma_f32_16x16x32_bf16 v[84:87], v[60:63], v[180:183], v[84:87]
ds_read_b64_tr_b16 v[52:53], v10 offset:49152
ds_read_b64_tr_b16 v[54:55], v10 offset:57344
v_mfma_f32_16x16x32_bf16 v[72:75], v[64:67], v[184:187], v[72:75]
buffer_load_dwordx4 v17, s[20:23], s94 offen offset:1024 lds
v_mfma_f32_16x16x32_bf16 v[76:79], v[64:67], v[188:191], v[76:79]
v_mfma_f32_16x16x32_bf16 v[80:83], v[68:71], v[184:187], v[80:83]
v_mfma_f32_16x16x32_bf16 v[84:87], v[68:71], v[188:191], v[84:87]
s_waitcnt lgkmcnt(6)
v_mfma_f32_16x16x32_bf16 v[72:75], v[40:43], v[192:195], v[72:75]
ds_read_b64_tr_b16 v[56:57], v9 offset:33792
ds_read_b64_tr_b16 v[58:59], v9 offset:41984
s_bfe_u32 s94, s70, 262156
s_lshl_b32 s94, s94, 15
s_add_u32 s94, s94, s76
s_sub_u32 s94, s94, 2048
buffer_load_dwordx4 v16, s[20:23], s94 offen offset:2048 lds
v_mfma_f32_16x16x32_bf16 v[76:79], v[40:43], v[196:199], v[76:79]
ds_read_b64_tr_b16 v[60:61], v10 offset:33792
ds_read_b64_tr_b16 v[62:63], v10 offset:41984
s_waitcnt lgkmcnt(8)
v_mfma_f32_16x16x32_bf16 v[80:83], v[44:47], v[192:195], v[80:83]
ds_read_b64_tr_b16 v[64:65], v9 offset:50176
ds_read_b64_tr_b16 v[66:67], v9 offset:58368
v_mfma_f32_16x16x32_bf16 v[84:87], v[44:47], v[196:199], v[84:87]
ds_read_b64_tr_b16 v[68:69], v10 offset:50176
ds_read_b64_tr_b16 v[70:71], v10 offset:58368
s_waitcnt lgkmcnt(10)
v_mfma_f32_16x16x32_bf16 v[72:75], v[48:51], v[200:203], v[72:75]
buffer_load_dwordx4 v17, s[20:23], s94 offen offset:3072 lds
v_mfma_f32_16x16x32_bf16 v[76:79], v[48:51], v[204:207], v[76:79]
s_waitcnt lgkmcnt(8)
v_mfma_f32_16x16x32_bf16 v[80:83], v[52:55], v[200:203], v[80:83]
v_mfma_f32_16x16x32_bf16 v[84:87], v[52:55], v[204:207], v[84:87]
s_waitcnt vmcnt(4) lgkmcnt(0)
s_barrier
s_cmp_lg_u32 s40, 7
s_cbranch_scc1 Lfs14
s_lshl_b32 s56, s46, 8
s_lshl_b32 s55, s43, 2
s_add_u32 s56, s56, s55
v_mov_b32 v32, s58
v_mov_b32 v33, 2147483648
v_writelane_b32 v33, 0, 0
buffer_store_dword v32, v33, s[24:27], s56 offen sc1
Lfs14:
v_mfma_f32_16x16x32_bf16 v[72:75], v[56:59], v[208:211], v[72:75]
ds_read_b64_tr_b16 v[40:41], v9 offset:34816
ds_read_b64_tr_b16 v[42:43], v9 offset:43008
s_add_u32 m0, s48, 0
s_bfe_u32 s94, s70, 262160
s_lshl_b32 s94, s94, 15
s_add_u32 s94, s94, s76
buffer_load_dwordx4 v16, s[20:23], s94 offen offset:0 lds
v_mfma_f32_16x16x32_bf16 v[76:79], v[56:59], v[212:215], v[76:79]
ds_read_b64_tr_b16 v[44:45], v10 offset:34816
ds_read_b64_tr_b16 v[46:47], v10 offset:43008
v_mfma_f32_16x16x32_bf16 v[80:83], v[60:63], v[208:211], v[80:83]
ds_read_b64_tr_b16 v[48:49], v9 offset:51200
ds_read_b64_tr_b16 v[50:51], v9 offset:59392
buffer_load_dwordx4 v17, s[20:23], s94 offen offset:1024 lds
v_mfma_f32_16x16x32_bf16 v[84:87], v[60:63], v[212:215], v[84:87]
ds_read_b64_tr_b16 v[52:53], v10 offset:51200
ds_read_b64_tr_b16 v[54:55], v10 offset:59392
v_mfma_f32_16x16x32_bf16 v[72:75], v[64:67], v[216:219], v[72:75]
s_bfe_u32 s94, s70, 262164
s_lshl_b32 s94, s94, 15
s_add_u32 s94, s94, s76
s_sub_u32 s94, s94, 2048
buffer_load_dwordx4 v16, s[20:23], s94 offen offset:2048 lds
v_mfma_f32_16x16x32_bf16 v[76:79], v[64:67], v[220:223], v[76:79]
v_mfma_f32_16x16x32_bf16 v[80:83], v[68:71], v[216:219], v[80:83]
buffer_load_dwordx4 v17, s[20:23], s94 offen offset:3072 lds
v_mfma_f32_16x16x32_bf16 v[84:87], v[68:71], v[220:223], v[84:87]
s_add_u32 s56, s65, 2048
buffer_load_dword v2, v22, s[24:27], s56 offen sc1
s_waitcnt lgkmcnt(6)
v_mfma_f32_16x16x32_bf16 v[72:75], v[40:43], v[224:227], v[72:75]
ds_read_b64_tr_b16 v[56:57], v9 offset:35840
ds_read_b64_tr_b16 v[58:59], v9 offset:44032
v_mfma_f32_16x16x32_bf16 v[76:79], v[40:43], v[228:231], v[76:79]
ds_read_b64_tr_b16 v[60:61], v10 offset:35840
ds_read_b64_tr_b16 v[62:63], v10 offset:44032
s_waitcnt lgkmcnt(8)
v_mfma_f32_16x16x32_bf16 v[80:83], v[44:47], v[224:227], v[80:83]
ds_read_b64_tr_b16 v[64:65], v9 offset:52224
ds_read_b64_tr_b16 v[66:67], v9 offset:60416
v_mfma_f32_16x16x32_bf16 v[84:87], v[44:47], v[228:231], v[84:87]
ds_read_b64_tr_b16 v[68:69], v10 offset:52224
ds_read_b64_tr_b16 v[70:71], v10 offset:60416
s_waitcnt lgkmcnt(10)
v_mfma_f32_16x16x32_bf16 v[72:75], v[48:51], v[232:235], v[72:75]
v_mfma_f32_16x16x32_bf16 v[76:79], v[48:51], v[236:239], v[76:79]
s_waitcnt lgkmcnt(8)
v_mfma_f32_16x16x32_bf16 v[80:83], v[52:55], v[232:235], v[80:83]
v_mfma_f32_16x16x32_bf16 v[84:87], v[52:55], v[236:239], v[84:87]
s_waitcnt lgkmcnt(6)
v_mfma_f32_16x16x32_bf16 v[72:75], v[56:59], v[240:243], v[72:75]
v_mfma_f32_16x16x32_bf16 v[76:79], v[56:59], v[244:247], v[76:79]
s_waitcnt lgkmcnt(4)
v_mfma_f32_16x16x32_bf16 v[80:83], v[60:63], v[240:243], v[80:83]
v_mfma_f32_16x16x32_bf16 v[84:87], v[60:63], v[244:247], v[84:87]
s_waitcnt lgkmcnt(2)
v_mfma_f32_16x16x32_bf16 v[72:75], v[64:67], v[248:251], v[72:75]
v_mfma_f32_16x16x32_bf16 v[76:79], v[64:67], v[252:255], v[76:79]
s_waitcnt lgkmcnt(0)
v_mfma_f32_16x16x32_bf16 v[80:83], v[68:71], v[248:251], v[80:83]
v_mfma_f32_16x16x32_bf16 v[84:87], v[68:71], v[252:255], v[84:87]
s_waitcnt vmcnt(0)
v_cmp_ne_u32 vcc, s58, v2
s_nop 0
s_cbranch_vccz Lok15
s_add_u32 s56, s65, 2048
s_mov_b32 s69, 0
Lsp16:
buffer_load_dword v2, v22, s[24:27], s56 offen sc1
s_add_u32 s69, s69, 1
s_waitcnt vmcnt(0)
v_cmp_ne_u32 vcc, s58, v2
s_cmp_ge_u32 s69, 0x100000
s_cbranch_scc1 Lok15
s_cbranch_vccnz Lsp16
Lok15:
s_bfe_u32 s93, s70, 262144
s_lshl_b32 s93, s93, 10
s_add_u32 s93, s93, s74
buffer_load_dwordx4 v[96:99], v15, s[24:27], s93 offen sc1
s_add_u32 s93, s93, 73728
buffer_load_dwordx4 v[100:103], v15, s[24:27], s93 offen sc1
v_cvt_pk_bf16_f32 v72, v72, v73
v_cvt_pk_bf16_f32 v73, v74, v75
v_cvt_pk_bf16_f32 v74, v76, v77
v_cvt_pk_bf16_f32 v75, v78, v79
v_pk_max_i16 v72, v72, 0
v_pk_max_i16 v73, v73, 0
v_pk_max_i16 v74, v74, 0
v_pk_max_i16 v75, v75, 0
s_nop 0
v_permlane32_swap_b32 v72, v74
v_permlane32_swap_b32 v73, v75
buffer_store_dwordx4 v[72:75], v14, s[24:27], s87 offen offset:0 sc1
s_bfe_u32 s93, s70, 262148
s_lshl_b32 s93, s93, 10
s_add_u32 s93, s93, s74
buffer_load_dwordx4 v[104:107], v15, s[24:27], s93 offen sc1
s_add_u32 s93, s93, 73728
buffer_load_dwordx4 v[108:111], v15, s[24:27], s93 offen sc1
v_cvt_pk_bf16_f32 v80, v80, v81
v_cvt_pk_bf16_f32 v81, v82, v83
v_cvt_pk_bf16_f32 v82, v84, v85
v_cvt_pk_bf16_f32 v83, v86, v87
v_pk_max_i16 v80, v80, 0
v_pk_max_i16 v81, v81, 0
v_pk_max_i16 v82, v82, 0
v_pk_max_i16 v83, v83, 0
s_nop 0
v_permlane32_swap_b32 v80, v82
v_permlane32_swap_b32 v81, v83
buffer_store_dwordx4 v[80:83], v14, s[24:27], s87 offen offset:512 sc1
s_bfe_u32 s93, s70, 262152
s_lshl_b32 s93, s93, 10
s_add_u32 s93, s93, s74
buffer_load_dwordx4 v[112:115], v15, s[24:27], s93 offen sc1
s_add_u32 s93, s93, 73728
buffer_load_dwordx4 v[116:119], v15, s[24:27], s93 offen sc1
s_barrier
v_xor_b32 v18, 65536, v18
v_xor_b32 v19, 65536, v19
v_xor_b32 v20, 65536, v20
v_xor_b32 v21, 65536, v21
ds_read_b64_tr_b16 v[40:41], v18 offset:0
ds_read_b64_tr_b16 v[42:43], v18 offset:16384
ds_read_b64_tr_b16 v[44:45], v19 offset:0
ds_read_b64_tr_b16 v[46:47], v19 offset:16384
ds_read_b64_tr_b16 v[48:49], v20 offset:0
ds_read_b64_tr_b16 v[50:51], v20 offset:16384
ds_read_b64_tr_b16 v[52:53], v21 offset:0
ds_read_b64_tr_b16 v[54:55], v21 offset:16384
s_add_u32 m0, s48, 32768
s_bfe_u32 s94, s70, 262168
s_lshl_b32 s94, s94, 15
s_add_u32 s94, s94, s76
buffer_load_dwordx4 v16, s[20:23], s94 offen offset:0 lds
buffer_load_dwordx4 v17, s[20:23], s94 offen offset:1024 lds
s_waitcnt lgkmcnt(6)
s_waitcnt vmcnt(8)
v_mfma_f32_16x16x32_bf16 v[128:131], v[40:43], v[96:99], 0
ds_read_b64_tr_b16 v[56:57], v18 offset:2048
ds_read_b64_tr_b16 v[58:59], v18 offset:18432
s_bfe_u32 s93, s70, 262156
s_lshl_b32 s93, s93, 10
s_add_u32 s93, s93, s74
buffer_load_dwordx4 v[120:123], v15, s[24:27], s93 offen sc1
v_mfma_f32_16x16x32_bf16 v[144:147], v[40:43], v[100:103], 0
ds_read_b64_tr_b16 v[60:61], v19 offset:2048
ds_read_b64_tr_b16 v[62:63], v19 offset:18432
s_add_u32 s93, s93, 73728
buffer_load_dwordx4 v[124:127], v15, s[24:27], s93 offen sc1
s_waitcnt lgkmcnt(8)
v_mfma_f32_16x16x32_bf16 v[132:135], v[44:47], v[96:99], 0
ds_read_b64_tr_b16 v[64:65], v20 offset:2048
ds_read_b64_tr_b16 v[66:67], v20 offset:18432
v_mfma_f32_16x16x32_bf16 v[148:151], v[44:47], v[100:103], 0
ds_read_b64_tr_b16 v[68:69], v21 offset:2048
ds_read_b64_tr_b16 v[70:71], v21 offset:18432
s_bfe_u32 s94, s70, 262172
s_lshl_b32 s94, s94, 15
s_add_u32 s94, s94, s76
s_sub_u32 s94, s94, 2048
buffer_load_dwordx4 v16, s[20:23], s94 offen offset:2048 lds
s_waitcnt lgkmcnt(10)
v_mfma_f32_16x16x32_bf16 v[136:139], v[48:51], v[96:99], 0
buffer_load_dwordx4 v17, s[20:23], s94 offen offset:3072 lds
v_mfma_f32_16x16x32_bf16 v[152:155], v[48:51], v[100:103], 0
s_waitcnt lgkmcnt(8)
v_mfma_f32_16x16x32_bf16 v[140:143], v[52:55], v[96:99], 0
v_mfma_f32_16x16x32_bf16 v[156:159], v[52:55], v[100:103], 0
s_waitcnt vmcnt(8) lgkmcnt(0)
s_barrier
s_cmp_lg_u32 s40, 7
s_cbranch_scc1 Lfs17
s_lshl_b32 s56, s43, 8
s_add_u32 s56, s56, 6144
s_add_u32 s56, s56, s82
v_mov_b32 v32, s58
v_mov_b32 v33, 2147483648
v_writelane_b32 v33, 0, 0
buffer_store_dword v32, v33, s[24:27], s56 offen sc1
Lfs17:
v_mfma_f32_16x16x32_bf16 v[128:131], v[56:59], v[104:107], v[128:131]
ds_read_b64_tr_b16 v[40:41], v18 offset:32768
ds_read_b64_tr_b16 v[42:43], v18 offset:49152
s_bfe_u32 s93, s70, 262160
s_lshl_b32 s93, s93, 10
s_add_u32 s93, s93, s74
buffer_load_dwordx4 v[192:195], v15, s[24:27], s93 offen sc1
v_mfma_f32_16x16x32_bf16 v[144:147], v[56:59], v[108:111], v[144:147]
ds_read_b64_tr_b16 v[44:45], v19 offset:32768
ds_read_b64_tr_b16 v[46:47], v19 offset:49152
s_add_u32 s93, s93, 73728
buffer_load_dwordx4 v[196:199], v15, s[24:27], s93 offen sc1
v_mfma_f32_16x16x32_bf16 v[132:135], v[60:63], v[104:107], v[132:135]
ds_read_b64_tr_b16 v[48:49], v20 offset:32768
ds_read_b64_tr_b16 v[50:51], v20 offset:49152
v_mfma_f32_16x16x32_bf16 v[148:151], v[60:63], v[108:111], v[148:151]
ds_read_b64_tr_b16 v[52:53], v21 offset:32768
ds_read_b64_tr_b16 v[54:55], v21 offset:49152
s_add_u32 m0, s48, 65536
s_bfe_u32 s94, s72, 262144
s_lshl_b32 s94, s94, 15
s_add_u32 s94, s94, s76
buffer_load_dwordx4 v16, s[20:23], s94 offen offset:0 lds
v_mfma_f32_16x16x32_bf16 v[136:139], v[64:67], v[104:107], v[136:139]
buffer_load_dwordx4 v17, s[20:23], s94 offen offset:1024 lds
v_mfma_f32_16x16x32_bf16 v[152:155], v[64:67], v[108:111], v[152:155]
v_mfma_f32_16x16x32_bf16 v[140:143], v[68:71], v[104:107], v[140:143]
v_mfma_f32_16x16x32_bf16 v[156:159], v[68:71], v[108:111], v[156:159]
s_waitcnt lgkmcnt(6)
s_waitcnt vmcnt(10)
v_mfma_f32_16x16x32_bf16 v[128:131], v[40:43], v[112:115], v[128:131]
ds_read_b64_tr_b16 v[56:57], v18 offset:34816
ds_read_b64_tr_b16 v[58:59], v18 offset:51200
s_bfe_u32 s93, s70, 262164
s_lshl_b32 s93, s93, 10
s_add_u32 s93, s93, s74
buffer_load_dwordx4 v[200:203], v15, s[24:27], s93 offen sc1
v_mfma_f32_16x16x32_bf16 v[144:147], v[40:43], v[116:119], v[144:147]
ds_read_b64_tr_b16 v[60:61], v19 offset:34816
ds_read_b64_tr_b16 v[62:63], v19 offset:51200
s_add_u32 s93, s93, 73728
buffer_load_dwordx4 v[204:207], v15, s[24:27], s93 offen sc1
s_waitcnt lgkmcnt(8)
v_mfma_f32_16x16x32_bf16 v[132:135], v[44:47], v[112:115], v[132:135]
ds_read_b64_tr_b16 v[64:65], v20 offset:34816
ds_read_b64_tr_b16 v[66:67], v20 offset:51200
v_mfma_f32_16x16x32_bf16 v[148:151], v[44:47], v[116:119], v[148:151]
ds_read_b64_tr_b16 v[68:69], v21 offset:34816
ds_read_b64_tr_b16 v[70:71], v21 offset:51200
s_bfe_u32 s94, s72, 262148
s_lshl_b32 s94, s94, 15
s_add_u32 s94, s94, s76
s_sub_u32 s94, s94, 2048
buffer_load_dwordx4 v16, s[20:23], s94 offen offset:2048 lds
s_waitcnt lgkmcnt(10)
v_mfma_f32_16x16x32_bf16 v[136:139], v[48:51], v[112:115], v[136:139]
buffer_load_dwordx4 v17, s[20:23], s94 offen offset:3072 lds
v_mfma_f32_16x16x32_bf16 v[152:155], v[48:51], v[116:119], v[152:155]
s_waitcnt lgkmcnt(8)
v_mfma_f32_16x16x32_bf16 v[140:143], v[52:55], v[112:115], v[140:143]
v_mfma_f32_16x16x32_bf16 v[156:159], v[52:55], v[116:119], v[156:159]
s_waitcnt lgkmcnt(0)
s_barrier
v_xor_b32 v18, 65536, v18
v_xor_b32 v19, 65536, v19
v_xor_b32 v20, 65536, v20
v_xor_b32 v21, 65536, v21
s_waitcnt vmcnt(10)
v_mfma_f32_16x16x32_bf16 v[128:131], v[56:59], v[120:123], v[128:131]
ds_read_b64_tr_b16 v[40:41], v18 offset:0
ds_read_b64_tr_b16 v[42:43], v18 offset:16384
s_bfe_u32 s93, s70, 262168
s_lshl_b32 s93, s93, 10
s_add_u32 s93, s93, s74
buffer_load_dwordx4 v[208:211], v15, s[24:27], s93 offen sc1
v_mfma_f32_16x16x32_bf16 v[144:147], v[56:59], v[124:127], v[144:147]
ds_read_b64_tr_b16 v[44:45], v19 offset:0
ds_read_b64_tr_b16 v[46:47], v19 offset:16384
s_add_u32 s93, s93, 73728
buffer_load_dwordx4 v[212:215], v15, s[24:27], s93 offen sc1
v_mfma_f32_16x16x32_bf16 v[132:135], v[60:63], v[120:123], v[132:135]
ds_read_b64_tr_b16 v[48:49], v20 offset:0
ds_read_b64_tr_b16 v[50:51], v20 offset:16384
v_mfma_f32_16x16x32_bf16 v[148:151], v[60:63], v[124:127], v[148:151]
ds_read_b64_tr_b16 v[52:53], v21 offset:0
ds_read_b64_tr_b16 v[54:55], v21 offset:16384
s_add_u32 m0, s48, 98304
s_bfe_u32 s94, s72, 262152
s_lshl_b32 s94, s94, 15
s_add_u32 s94, s94, s76
buffer_load_dwordx4 v16, s[20:23], s94 offen offset:0 lds
v_mfma_f32_16x16x32_bf16 v[136:139], v[64:67], v[120:123], v[136:139]
buffer_load_dwordx4 v17, s[20:23], s94 offen offset:1024 lds
v_mfma_f32_16x16x32_bf16 v[152:155], v[64:67], v[124:127], v[152:155]
v_mfma_f32_16x16x32_bf16 v[140:143], v[68:71], v[120:123], v[140:143]
v_mfma_f32_16x16x32_bf16 v[156:159], v[68:71], v[124:127], v[156:159]
s_add_u32 s56, s65, 6144
buffer_load_dword v34, v12, s[24:27], s56 offen sc1
s_waitcnt lgkmcnt(6)
s_waitcnt vmcnt(11)
v_mfma_f32_16x16x32_bf16 v[128:131], v[40:43], v[192:195], v[128:131]
ds_read_b64_tr_b16 v[56:57], v18 offset:2048
ds_read_b64_tr_b16 v[58:59], v18 offset:18432
s_bfe_u32 s93, s70, 262172
s_lshl_b32 s93, s93, 10
s_add_u32 s93, s93, s74
buffer_load_dwordx4 v[216:219], v15, s[24:27], s93 offen sc1
v_mfma_f32_16x16x32_bf16 v[144:147], v[40:43], v[196:199], v[144:147]
ds_read_b64_tr_b16 v[60:61], v19 offset:2048
ds_read_b64_tr_b16 v[62:63], v19 offset:18432
s_add_u32 s93, s93, 73728
buffer_load_dwordx4 v[220:223], v15, s[24:27], s93 offen sc1
s_waitcnt lgkmcnt(8)
v_mfma_f32_16x16x32_bf16 v[132:135], v[44:47], v[192:195], v[132:135]
ds_read_b64_tr_b16 v[64:65], v20 offset:2048
ds_read_b64_tr_b16 v[66:67], v20 offset:18432
v_mfma_f32_16x16x32_bf16 v[148:151], v[44:47], v[196:199], v[148:151]
ds_read_b64_tr_b16 v[68:69], v21 offset:2048
ds_read_b64_tr_b16 v[70:71], v21 offset:18432
s_bfe_u32 s94, s72, 262156
s_lshl_b32 s94, s94, 15
s_add_u32 s94, s94, s76
s_sub_u32 s94, s94, 2048
buffer_load_dwordx4 v16, s[20:23], s94 offen offset:2048 lds
s_waitcnt lgkmcnt(10)
v_mfma_f32_16x16x32_bf16 v[136:139], v[48:51], v[192:195], v[136:139]
buffer_load_dwordx4 v17, s[20:23], s94 offen offset:3072 lds
v_mfma_f32_16x16x32_bf16 v[152:155], v[48:51], v[196:199], v[152:155]
s_waitcnt lgkmcnt(8)
v_mfma_f32_16x16x32_bf16 v[140:143], v[52:55], v[192:195], v[140:143]
v_mfma_f32_16x16x32_bf16 v[156:159], v[52:55], v[196:199], v[156:159]
s_waitcnt lgkmcnt(0)
s_barrier
s_waitcnt vmcnt(4)
v_cmp_ne_u32 vcc, s58, v34
s_nop 0
s_cbranch_vccz Lok18
s_add_u32 s56, s65, 6144
s_mov_b32 s69, 0
Lsp19:
buffer_load_dword v34, v12, s[24:27], s56 offen sc1
s_add_u32 s69, s69, 1
s_waitcnt vmcnt(0)
v_cmp_ne_u32 vcc, s58, v34
s_cmp_ge_u32 s69, 0x100000
s_cbranch_scc1 Lok18
s_cbranch_vccnz Lsp19
Lok18:
v_mfma_f32_16x16x32_bf16 v[128:131], v[56:59], v[200:203], v[128:131]
ds_read_b64_tr_b16 v[40:41], v18 offset:32768
ds_read_b64_tr_b16 v[42:43], v18 offset:49152
s_bfe_u32 s93, s72, 262144
s_lshl_b32 s93, s93, 10
s_add_u32 s93, s93, s74
buffer_load_dwordx4 v[96:99], v15, s[24:27], s93 offen sc1
v_mfma_f32_16x16x32_bf16 v[144:147], v[56:59], v[204:207], v[144:147]
ds_read_b64_tr_b16 v[44:45], v19 offset:32768
ds_read_b64_tr_b16 v[46:47], v19 offset:49152
s_add_u32 s93, s93, 73728
buffer_load_dwordx4 v[100:103], v15, s[24:27], s93 offen sc1
v_mfma_f32_16x16x32_bf16 v[132:135], v[60:63], v[200:203], v[132:135]
ds_read_b64_tr_b16 v[48:49], v20 offset:32768
ds_read_b64_tr_b16 v[50:51], v20 offset:49152
v_mfma_f32_16x16x32_bf16 v[148:151], v[60:63], v[204:207], v[148:151]
ds_read_b64_tr_b16 v[52:53], v21 offset:32768
ds_read_b64_tr_b16 v[54:55], v21 offset:49152
s_add_u32 m0, s48, 0
s_bfe_u32 s94, s72, 262160
s_lshl_b32 s94, s94, 15
s_add_u32 s94, s94, s76
buffer_load_dwordx4 v16, s[20:23], s94 offen offset:0 lds
v_mfma_f32_16x16x32_bf16 v[136:139], v[64:67], v[200:203], v[136:139]
buffer_load_dwordx4 v17, s[20:23], s94 offen offset:1024 lds
v_mfma_f32_16x16x32_bf16 v[152:155], v[64:67], v[204:207], v[152:155]
v_mfma_f32_16x16x32_bf16 v[140:143], v[68:71], v[200:203], v[140:143]
v_mfma_f32_16x16x32_bf16 v[156:159], v[68:71], v[204:207], v[156:159]
s_waitcnt lgkmcnt(6)
v_mfma_f32_16x16x32_bf16 v[128:131], v[40:43], v[208:211], v[128:131]
ds_read_b64_tr_b16 v[56:57], v18 offset:34816
ds_read_b64_tr_b16 v[58:59], v18 offset:51200
s_bfe_u32 s93, s72, 262148
s_lshl_b32 s93, s93, 10
s_add_u32 s93, s93, s74
buffer_load_dwordx4 v[104:107], v15, s[24:27], s93 offen sc1
v_mfma_f32_16x16x32_bf16 v[144:147], v[40:43], v[212:215], v[144:147]
ds_read_b64_tr_b16 v[60:61], v19 offset:34816
ds_read_b64_tr_b16 v[62:63], v19 offset:51200
s_add_u32 s93, s93, 73728
buffer_load_dwordx4 v[108:111], v15, s[24:27], s93 offen sc1
s_waitcnt lgkmcnt(8)
v_mfma_f32_16x16x32_bf16 v[132:135], v[44:47], v[208:211], v[132:135]
ds_read_b64_tr_b16 v[64:65], v20 offset:34816
ds_read_b64_tr_b16 v[66:67], v20 offset:51200
v_mfma_f32_16x16x32_bf16 v[148:151], v[44:47], v[212:215], v[148:151]
ds_read_b64_tr_b16 v[68:69], v21 offset:34816
ds_read_b64_tr_b16 v[70:71], v21 offset:51200
s_bfe_u32 s94, s72, 262164
s_lshl_b32 s94, s94, 15
s_add_u32 s94, s94, s76
s_sub_u32 s94, s94, 2048
buffer_load_dwordx4 v16, s[20:23], s94 offen offset:2048 lds
s_waitcnt lgkmcnt(10)
v_mfma_f32_16x16x32_bf16 v[136:139], v[48:51], v[208:211], v[136:139]
buffer_load_dwordx4 v17, s[20:23], s94 offen offset:3072 lds
v_mfma_f32_16x16x32_bf16 v[152:155], v[48:51], v[212:215], v[152:155]
s_waitcnt lgkmcnt(8)
v_mfma_f32_16x16x32_bf16 v[140:143], v[52:55], v[208:211], v[140:143]
v_mfma_f32_16x16x32_bf16 v[156:159], v[52:55], v[212:215], v[156:159]
s_waitcnt lgkmcnt(0)
s_barrier
v_xor_b32 v18, 65536, v18
v_xor_b32 v19, 65536, v19
v_xor_b32 v20, 65536, v20
v_xor_b32 v21, 65536, v21
s_waitcnt vmcnt(10)
v_mfma_f32_16x16x32_bf16 v[128:131], v[56:59], v[216:219], v[128:131]
ds_read_b64_tr_b16 v[40:41], v18 offset:0
ds_read_b64_tr_b16 v[42:43], v18 offset:16384
s_bfe_u32 s93, s72, 262152
s_lshl_b32 s93, s93, 10
s_add_u32 s93, s93, s74
buffer_load_dwordx4 v[112:115], v15, s[24:27], s93 offen sc1
v_and_b32 v23, 15, v1
v_mfma_f32_16x16x32_bf16 v[144:147], v[56:59], v[220:223], v[144:147]
ds_read_b64_tr_b16 v[44:45], v19 offset:0
ds_read_b64_tr_b16 v[46:47], v19 offset:16384
s_add_u32 s93, s93, 73728
buffer_load_dwordx4 v[116:119], v15, s[24:27], s93 offen sc1
v_lshrrev_b32 v24, 4, v1
v_mfma_f32_16x16x32_bf16 v[132:135], v[60:63], v[216:219], v[132:135]
ds_read_b64_tr_b16 v[48:49], v20 offset:0
ds_read_b64_tr_b16 v[50:51], v20 offset:16384
v_and_b32 v25, 7, v1
v_mfma_f32_16x16x32_bf16 v[148:151], v[60:63], v[220:223], v[148:151]
ds_read_b64_tr_b16 v[52:53], v21 offset:0
ds_read_b64_tr_b16 v[54:55], v21 offset:16384
s_add_u32 m0, s48, 32768
s_bfe_u32 s94, s71, 262144
s_lshl_b32 s94, s94, 15
s_add_u32 s94, s94, s77
buffer_load_dwordx4 v16, s[16:19], s94 offen offset:0 lds
v_xor_b32 v24, v24, v25
v_mfma_f32_16x16x32_bf16 v[136:139], v[64:67], v[216:219], v[136:139]
buffer_load_dwordx4 v17, s[16:19], s94 offen offset:1024 lds
v_lshlrev_b32 v24, 4, v24
v_mfma_f32_16x16x32_bf16 v[152:155], v[64:67], v[220:223], v[152:155]
v_lshl_add_u32 v23, v23, 8, v24
v_mfma_f32_16x16x32_bf16 v[140:143], v[68:71], v[216:219], v[140:143]
s_lshl1_add_u32 s53, s41, s42
v_mfma_f32_16x16x32_bf16 v[156:159], v[68:71], v[220:223], v[156:159]
s_waitcnt lgkmcnt(6)
s_waitcnt vmcnt(10)
v_mfma_f32_16x16x32_bf16 v[128:131], v[40:43], v[96:99], v[128:131]
ds_read_b64_tr_b16 v[56:57], v18 offset:2048
ds_read_b64_tr_b16 v[58:59], v18 offset:18432
s_bfe_u32 s93, s72, 262156
s_lshl_b32 s93, s93, 10
s_add_u32 s93, s93, s74
buffer_load_dwordx4 v[120:123], v15, s[24:27], s93 offen sc1
s_lshl_b32 s53, s53, 13
v_mfma_f32_16x16x32_bf16 v[144:147], v[40:43], v[100:103], v[144:147]
ds_read_b64_tr_b16 v[60:61], v19 offset:2048
ds_read_b64_tr_b16 v[62:63], v19 offset:18432
s_add_u32 s93, s93, 73728
buffer_load_dwordx4 v[124:127], v15, s[24:27], s93 offen sc1
s_add_u32 s53, s53, 0
s_waitcnt lgkmcnt(8)
v_mfma_f32_16x16x32_bf16 v[132:135], v[44:47], v[96:99], v[132:135]
ds_read_b64_tr_b16 v[64:65], v20 offset:2048
ds_read_b64_tr_b16 v[66:67], v20 offset:18432
v_add_u32 v7, s53, v23
v_mfma_f32_16x16x32_bf16 v[148:151], v[44:47], v[100:103], v[148:151]
ds_read_b64_tr_b16 v[68:69], v21 offset:2048
ds_read_b64_tr_b16 v[70:71], v21 offset:18432
s_bfe_u32 s94, s71, 262148
s_lshl_b32 s94, s94, 15
s_add_u32 s94, s94, s77
s_sub_u32 s94, s94, 2048
buffer_load_dwordx4 v16, s[16:19], s94 offen offset:2048 lds
v_xor_b32 v8, 64, v7
s_waitcnt lgkmcnt(10)
v_mfma_f32_16x16x32_bf16 v[136:139], v[48:51], v[96:99], v[136:139]
buffer_load_dwordx4 v17, s[16:19], s94 offen offset:3072 lds
v_lshrrev_b32 v30, 3, v1
v_mfma_f32_16x16x32_bf16 v[152:155], v[48:51], v[100:103], v[152:155]
v_and_b32 v23, 3, v1
s_waitcnt lgkmcnt(8)
v_mfma_f32_16x16x32_bf16 v[140:143], v[52:55], v[96:99], v[140:143]
v_lshlrev_b32 v23, 1, v23
v_mfma_f32_16x16x32_bf16 v[156:159], v[52:55], v[100:103], v[156:159]
v_xor_b32 v23, v23, v30
s_waitcnt lgkmcnt(0)
s_barrier
s_waitcnt vmcnt(10)
v_mfma_f32_16x16x32_bf16 v[128:131], v[56:59], v[104:107], v[128:131]
ds_read_b64_tr_b16 v[40:41], v18 offset:32768
ds_read_b64_tr_b16 v[42:43], v18 offset:49152
s_bfe_u32 s93, s72, 262160
s_lshl_b32 s93, s93, 10
s_add_u32 s93, s93, s74
buffer_load_dwordx4 v[192:195], v15, s[24:27], s93 offen sc1
v_and_b32 v28, 15, v1
v_lshlrev_b32 v28, 2, v28
v_mfma_f32_16x16x32_bf16 v[144:147], v[56:59], v[108:111], v[144:147]
ds_read_b64_tr_b16 v[44:45], v19 offset:32768
ds_read_b64_tr_b16 v[46:47], v19 offset:49152
s_add_u32 s93, s93, 73728
buffer_load_dwordx4 v[196:199], v15, s[24:27], s93 offen sc1
s_lshl1_add_u32 s55, s59, s42
s_lshl_b32 s55, s55, 7
v_mfma_f32_16x16x32_bf16 v[132:135], v[60:63], v[104:107], v[132:135]
ds_read_b64_tr_b16 v[48:49], v20 offset:32768
ds_read_b64_tr_b16 v[50:51], v20 offset:49152
s_add_u32 s55, s55, 65536
buffer_load_dword v26, v28, s[24:27], s55 offen sc1
v_mfma_f32_16x16x32_bf16 v[148:151], v[60:63], v[108:111], v[148:151]
ds_read_b64_tr_b16 v[52:53], v21 offset:32768
ds_read_b64_tr_b16 v[54:55], v21 offset:49152
s_add_u32 m0, s48, 65536
s_bfe_u32 s94, s71, 262152
s_lshl_b32 s94, s94, 15
s_add_u32 s94, s94, s77
buffer_load_dwordx4 v16, s[16:19], s94 offen offset:0 lds
buffer_load_dword v27, v28, s[24:27], s55 offen offset:64 sc1
v_mfma_f32_16x16x32_bf16 v[136:139], v[64:67], v[104:107], v[136:139]
buffer_load_dwordx4 v17, s[16:19], s94 offen offset:1024 lds
v_lshlrev_b32 v23, 4, v23
v_bfe_u32 v24, v1, 2, 1
v_mfma_f32_16x16x32_bf16 v[152:155], v[64:67], v[108:111], v[152:155]
v_lshl_add_u32 v23, v24, 7, v23
v_lshl_add_u32 v23, v30, 8, v23
v_mfma_f32_16x16x32_bf16 v[140:143], v[68:71], v[104:107], v[140:143]
s_lshl_b32 s53, s40, 11
s_add_u32 s53, s53, 0
v_mfma_f32_16x16x32_bf16 v[156:159], v[68:71], v[108:111], v[156:159]
v_add_u32 v9, s53, v23
s_add_u32 s56, s65, 10240
buffer_load_dword v34, v22, s[24:27], s56 offen sc1
s_waitcnt lgkmcnt(6)
s_waitcnt vmcnt(13)
v_mfma_f32_16x16x32_bf16 v[128:131], v[40:43], v[112:115], v[128:131]
ds_read_b64_tr_b16 v[56:57], v18 offset:34816
ds_read_b64_tr_b16 v[58:59], v18 offset:51200
s_bfe_u32 s93, s72, 262164
s_lshl_b32 s93, s93, 10
s_add_u32 s93, s93, s74
buffer_load_dwordx4 v[200:203], v15, s[24:27], s93 offen sc1
v_xor_b32 v10, 16, v9
v_mfma_f32_16x16x32_bf16 v[144:147], v[40:43], v[116:119], v[144:147]
ds_read_b64_tr_b16 v[60:61], v19 offset:34816
ds_read_b64_tr_b16 v[62:63], v19 offset:51200
s_add_u32 s93, s93, 73728
buffer_load_dwordx4 v[204:207], v15, s[24:27], s93 offen sc1
s_lshl_b32 s53, s40, 13
s_waitcnt lgkmcnt(8)
v_mfma_f32_16x16x32_bf16 v[132:135], v[44:47], v[112:115], v[132:135]
ds_read_b64_tr_b16 v[64:65], v20 offset:34816
ds_read_b64_tr_b16 v[66:67], v20 offset:51200
v_lshlrev_b32 v30, 10, v30
v_mfma_f32_16x16x32_bf16 v[148:151], v[44:47], v[116:119], v[148:151]
ds_read_b64_tr_b16 v[68:69], v21 offset:34816
ds_read_b64_tr_b16 v[70:71], v21 offset:51200
s_bfe_u32 s94, s71, 262156
s_lshl_b32 s94, s94, 15
s_add_u32 s94, s94, s77
s_sub_u32 s94, s94, 2048
buffer_load_dwordx4 v16, s[16:19], s94 offen offset:2048 lds
v_lshl_add_u32 v30, v25, 4, v30
s_waitcnt lgkmcnt(10)
v_mfma_f32_16x16x32_bf16 v[136:139], v[48:51], v[112:115], v[136:139]
buffer_load_dwordx4 v17, s[16:19], s94 offen offset:3072 lds
s_lshl_b32 s54, s59, 16
v_mfma_f32_16x16x32_bf16 v[152:155], v[48:51], v[116:119], v[152:155]
s_add_u32 s53, s53, s54
s_waitcnt lgkmcnt(8)
v_mfma_f32_16x16x32_bf16 v[140:143], v[52:55], v[112:115], v[140:143]
s_lshl_b32 s54, s60, 7
v_mfma_f32_16x16x32_bf16 v[156:159], v[52:55], v[116:119], v[156:159]
s_add_u32 s53, s53, s54
s_waitcnt lgkmcnt(0)
s_barrier
v_xor_b32 v18, 65536, v18
v_xor_b32 v19, 65536, v19
v_xor_b32 v20, 65536, v20
v_xor_b32 v21, 65536, v21
s_waitcnt vmcnt(4)
v_cmp_ne_u32 vcc, s58, v34
s_nop 0
s_cbranch_vccz Lok20
s_add_u32 s56, s65, 10240
s_mov_b32 s69, 0
Lsp21:
buffer_load_dword v34, v22, s[24:27], s56 offen sc1
s_add_u32 s69, s69, 1
s_waitcnt vmcnt(0)
v_cmp_ne_u32 vcc, s58, v34
s_cmp_ge_u32 s69, 0x100000
s_cbranch_scc1 Lok20
s_cbranch_vccnz Lsp21
Lok20:
v_mfma_f32_16x16x32_bf16 v[128:131], v[56:59], v[120:123], v[128:131]
ds_read_b64_tr_b16 v[40:41], v18 offset:0
ds_read_b64_tr_b16 v[42:43], v18 offset:16384
s_bfe_u32 s93, s71, 262144
s_lshl_b32 s93, s93, 10
s_add_u32 s93, s93, s75
buffer_load_dwordx4 v[208:211], v15, s[24:27], s93 offen sc1
v_mfma_f32_16x16x32_bf16 v[144:147], v[56:59], v[124:127], v[144:147]
ds_read_b64_tr_b16 v[44:45], v19 offset:0
ds_read_b64_tr_b16 v[46:47], v19 offset:16384
v_mfma_f32_16x16x32_bf16 v[132:135], v[60:63], v[120:123], v[132:135]
ds_read_b64_tr_b16 v[48:49], v20 offset:0
ds_read_b64_tr_b16 v[50:51], v20 offset:16384
v_mfma_f32_16x16x32_bf16 v[148:151], v[60:63], v[124:127], v[148:151]
ds_read_b64_tr_b16 v[52:53], v21 offset:0
ds_read_b64_tr_b16 v[54:55], v21 offset:16384
s_add_u32 s93, s93, 73728
buffer_load_dwordx4 v[212:215], v15, s[24:27], s93 offen sc1
v_mfma_f32_16x16x32_bf16 v[136:139], v[64:67], v[120:123], v[136:139]
v_mfma_f32_16x16x32_bf16 v[152:155], v[64:67], v[124:127], v[152:155]
v_mfma_f32_16x16x32_bf16 v[140:143], v[68:71], v[120:123], v[140:143]
v_mfma_f32_16x16x32_bf16 v[156:159], v[68:71], v[124:127], v[156:159]
s_waitcnt lgkmcnt(6)
v_mfma_f32_16x16x32_bf16 v[128:131], v[40:43], v[192:195], v[128:131]
ds_read_b64_tr_b16 v[56:57], v18 offset:2048
ds_read_b64_tr_b16 v[58:59], v18 offset:18432
s_bfe_u32 s93, s71, 262148
s_lshl_b32 s93, s93, 10
s_add_u32 s93, s93, s75
buffer_load_dwordx4 v[216:219], v15, s[24:27], s93 offen sc1
v_mfma_f32_16x16x32_bf16 v[144:147], v[40:43], v[196:199], v[144:147]
ds_read_b64_tr_b16 v[60:61], v19 offset:2048
ds_read_b64_tr_b16 v[62:63], v19 offset:18432
s_waitcnt lgkmcnt(8)
v_mfma_f32_16x16x32_bf16 v[132:135], v[44:47], v[192:195], v[132:135]
ds_read_b64_tr_b16 v[64:65], v20 offset:2048
ds_read_b64_tr_b16 v[66:67], v20 offset:18432
v_sub_f32 v28, 1.0, v26
v_mfma_f32_16x16x32_bf16 v[148:151], v[44:47], v[196:199], v[148:151]
ds_read_b64_tr_b16 v[68:69], v21 offset:2048
ds_read_b64_tr_b16 v[70:71], v21 offset:18432
s_add_u32 s93, s93, 73728
buffer_load_dwordx4 v[220:223], v15, s[24:27], s93 offen sc1
s_waitcnt lgkmcnt(10)
v_mfma_f32_16x16x32_bf16 v[136:139], v[48:51], v[192:195], v[136:139]
v_mfma_f32_16x16x32_bf16 v[152:155], v[48:51], v[196:199], v[152:155]
v_sub_f32 v29, 1.0, v27
s_waitcnt lgkmcnt(8)
v_mfma_f32_16x16x32_bf16 v[140:143], v[52:55], v[192:195], v[140:143]
v_mfma_f32_16x16x32_bf16 v[156:159], v[52:55], v[196:199], v[156:159]
s_waitcnt lgkmcnt(0)
s_barrier
s_waitcnt vmcnt(6)
v_mfma_f32_16x16x32_bf16 v[128:131], v[56:59], v[200:203], v[128:131]
ds_read_b64_tr_b16 v[40:41], v18 offset:32768
ds_read_b64_tr_b16 v[42:43], v18 offset:49152
s_bfe_u32 s93, s71, 262152
s_lshl_b32 s93, s93, 10
s_add_u32 s93, s93, s75
buffer_load_dwordx4 v[96:99], v15, s[24:27], s93 offen sc1
v_mfma_f32_16x16x32_bf16 v[144:147], v[56:59], v[204:207], v[144:147]
ds_read_b64_tr_b16 v[44:45], v19 offset:32768
ds_read_b64_tr_b16 v[46:47], v19 offset:49152
v_mfma_f32_16x16x32_bf16 v[132:135], v[60:63], v[200:203], v[132:135]
ds_read_b64_tr_b16 v[48:49], v20 offset:32768
ds_read_b64_tr_b16 v[50:51], v20 offset:49152
v_mfma_f32_16x16x32_bf16 v[148:151], v[60:63], v[204:207], v[148:151]
ds_read_b64_tr_b16 v[52:53], v21 offset:32768
ds_read_b64_tr_b16 v[54:55], v21 offset:49152
s_add_u32 s93, s93, 73728
buffer_load_dwordx4 v[100:103], v15, s[24:27], s93 offen sc1
v_mfma_f32_16x16x32_bf16 v[136:139], v[64:67], v[200:203], v[136:139]
v_mfma_f32_16x16x32_bf16 v[152:155], v[64:67], v[204:207], v[152:155]
v_mfma_f32_16x16x32_bf16 v[140:143], v[68:71], v[200:203], v[140:143]
v_mfma_f32_16x16x32_bf16 v[156:159], v[68:71], v[204:207], v[156:159]
s_waitcnt lgkmcnt(6)
s_waitcnt vmcnt(4)
v_mfma_f32_16x16x32_bf16 v[160:163], v[40:43], v[208:211], 0
ds_read_b64_tr_b16 v[56:57], v18 offset:34816
ds_read_b64_tr_b16 v[58:59], v18 offset:51200
s_bfe_u32 s93, s71, 262156
s_lshl_b32 s93, s93, 10
s_add_u32 s93, s93, s75
buffer_load_dwordx4 v[104:107], v15, s[24:27], s93 offen sc1
v_mul_f32 v128, v128, v28
v_mul_f32 v129, v129, v28
v_mfma_f32_16x16x32_bf16 v[176:179], v[40:43], v[212:215], 0
ds_read_b64_tr_b16 v[60:61], v19 offset:34816
ds_read_b64_tr_b16 v[62:63], v19 offset:51200
v_mul_f32 v130, v130, v28
v_mul_f32 v131, v131, v28
s_waitcnt lgkmcnt(8)
v_mfma_f32_16x16x32_bf16 v[164:167], v[44:47], v[208:211], 0
ds_read_b64_tr_b16 v[64:65], v20 offset:34816
ds_read_b64_tr_b16 v[66:67], v20 offset:51200
v_mul_f32 v132, v132, v28
v_mul_f32 v133, v133, v28
v_mfma_f32_16x16x32_bf16 v[180:183], v[44:47], v[212:215], 0
ds_read_b64_tr_b16 v[68:69], v21 offset:34816
ds_read_b64_tr_b16 v[70:71], v21 offset:51200
s_add_u32 s93, s93, 73728
buffer_load_dwordx4 v[108:111], v15, s[24:27], s93 offen sc1
v_mul_f32 v134, v134, v28
v_mul_f32 v135, v135, v28
s_waitcnt lgkmcnt(10)
v_mfma_f32_16x16x32_bf16 v[168:171], v[48:51], v[208:211], 0
v_mul_f32 v136, v136, v28
v_mul_f32 v137, v137, v28
v_mfma_f32_16x16x32_bf16 v[184:187], v[48:51], v[212:215], 0
v_mul_f32 v138, v138, v28
v_mul_f32 v139, v139, v28
s_waitcnt lgkmcnt(8)
v_mfma_f32_16x16x32_bf16 v[172:175], v[52:55], v[208:211], 0
v_mul_f32 v140, v140, v28
v_mul_f32 v141, v141, v28
v_mfma_f32_16x16x32_bf16 v[188:191], v[52:55], v[212:215], 0
v_mul_f32 v142, v142, v28
v_mul_f32 v143, v143, v28
s_waitcnt lgkmcnt(0)
s_barrier
v_xor_b32 v18, 65536, v18
v_xor_b32 v19, 65536, v19
v_xor_b32 v20, 65536, v20
v_xor_b32 v21, 65536, v21
s_waitcnt vmcnt(4)
v_mfma_f32_16x16x32_bf16 v[160:163], v[56:59], v[216:219], v[160:163]
ds_read_b64_tr_b16 v[40:41], v18 offset:0
ds_read_b64_tr_b16 v[42:43], v18 offset:16384
v_mul_f32 v144, v144, v29
v_mul_f32 v145, v145, v29
v_mfma_f32_16x16x32_bf16 v[176:179], v[56:59], v[220:223], v[176:179]
ds_read_b64_tr_b16 v[56:57], v18 offset:2048
ds_read_b64_tr_b16 v[58:59], v18 offset:18432
ds_read_b64_tr_b16 v[44:45], v19 offset:0
ds_read_b64_tr_b16 v[46:47], v19 offset:16384
v_mul_f32 v146, v146, v29
v_mul_f32 v147, v147, v29
v_mfma_f32_16x16x32_bf16 v[164:167], v[60:63], v[216:219], v[164:167]
ds_read_b64_tr_b16 v[48:49], v20 offset:0
ds_read_b64_tr_b16 v[50:51], v20 offset:16384
v_mul_f32 v148, v148, v29
v_mul_f32 v149, v149, v29
v_mfma_f32_16x16x32_bf16 v[180:183], v[60:63], v[220:223], v[180:183]
ds_read_b64_tr_b16 v[60:61], v19 offset:2048
ds_read_b64_tr_b16 v[62:63], v19 offset:18432
ds_read_b64_tr_b16 v[52:53], v21 offset:0
ds_read_b64_tr_b16 v[54:55], v21 offset:16384
v_mul_f32 v150, v150, v29
v_mul_f32 v151, v151, v29
v_mfma_f32_16x16x32_bf16 v[168:171], v[64:67], v[216:219], v[168:171]
v_mul_f32 v152, v152, v29
v_mul_f32 v153, v153, v29
v_mfma_f32_16x16x32_bf16 v[184:187], v[64:67], v[220:223], v[184:187]
ds_read_b64_tr_b16 v[64:65], v20 offset:2048
ds_read_b64_tr_b16 v[66:67], v20 offset:18432
v_mul_f32 v154, v154, v29
v_mul_f32 v155, v155, v29
v_mfma_f32_16x16x32_bf16 v[172:175], v[68:71], v[216:219], v[172:175]
v_mul_f32 v156, v156, v29
v_mul_f32 v157, v157, v29
v_mfma_f32_16x16x32_bf16 v[188:191], v[68:71], v[220:223], v[188:191]
ds_read_b64_tr_b16 v[68:69], v21 offset:2048
ds_read_b64_tr_b16 v[70:71], v21 offset:18432
v_mul_f32 v158, v158, v29
v_mul_f32 v159, v159, v29
s_waitcnt lgkmcnt(14)
s_waitcnt vmcnt(2)
v_mfma_f32_16x16x32_bf16 v[160:163], v[40:43], v[96:99], v[160:163]
v_mfma_f32_16x16x32_bf16 v[176:179], v[40:43], v[100:103], v[176:179]
s_waitcnt lgkmcnt(12)
s_waitcnt vmcnt(0)
v_mfma_f32_16x16x32_bf16 v[160:163], v[56:59], v[104:107], v[160:163]
v_mfma_f32_16x16x32_bf16 v[176:179], v[56:59], v[108:111], v[176:179]
s_waitcnt lgkmcnt(10)
v_mfma_f32_16x16x32_bf16 v[164:167], v[44:47], v[96:99], v[164:167]
v_mfma_f32_16x16x32_bf16 v[180:183], v[44:47], v[100:103], v[180:183]
s_nop 3
v_fmac_f32 v128, v160, v26
v_fmac_f32 v129, v161, v26
v_fmac_f32 v130, v162, v26
v_fmac_f32 v131, v163, v26
ds_write_b128 v7, v[128:131] offset:0
s_waitcnt lgkmcnt(7)
v_mfma_f32_16x16x32_bf16 v[164:167], v[60:63], v[104:107], v[164:167]
v_mfma_f32_16x16x32_bf16 v[180:183], v[60:63], v[108:111], v[180:183]
v_fmac_f32 v144, v176, v27
v_fmac_f32 v145, v177, v27
v_fmac_f32 v146, v178, v27
v_fmac_f32 v147, v179, v27
ds_write_b128 v7, v[144:147] offset:4096
v_mfma_f32_16x16x32_bf16 v[168:171], v[48:51], v[96:99], v[168:171]
v_mfma_f32_16x16x32_bf16 v[184:187], v[48:51], v[100:103], v[184:187]
v_fmac_f32 v132, v164, v26
v_fmac_f32 v133, v165, v26
v_fmac_f32 v134, v166, v26
v_fmac_f32 v135, v167, v26
ds_write_b128 v8, v[132:135] offset:0
s_waitcnt lgkmcnt(5)
v_mfma_f32_16x16x32_bf16 v[168:171], v[64:67], v[104:107], v[168:171]
v_mfma_f32_16x16x32_bf16 v[184:187], v[64:67], v[108:111], v[184:187]
v_fmac_f32 v148, v180, v27
v_fmac_f32 v149, v181, v27
v_fmac_f32 v150, v182, v27
v_fmac_f32 v151, v183, v27
ds_write_b128 v8, v[148:151] offset:4096
v_mfma_f32_16x16x32_bf16 v[172:175], v[52:55], v[96:99], v[172:175]
v_mfma_f32_16x16x32_bf16 v[188:191], v[52:55], v[100:103], v[188:191]
v_fmac_f32 v136, v168, v26
v_fmac_f32 v137, v169, v26
v_fmac_f32 v138, v170, v26
v_fmac_f32 v139, v171, v26
ds_write_b128 v7, v[136:139] offset:128
s_waitcnt lgkmcnt(5)
v_mfma_f32_16x16x32_bf16 v[172:175], v[68:71], v[104:107], v[172:175]
v_mfma_f32_16x16x32_bf16 v[188:191], v[68:71], v[108:111], v[188:191]
v_fmac_f32 v152, v184, v27
v_fmac_f32 v153, v185, v27
v_fmac_f32 v154, v186, v27
v_fmac_f32 v155, v187, v27
ds_write_b128 v7, v[152:155] offset:4224
s_nop 1
v_fmac_f32 v140, v172, v26
v_fmac_f32 v141, v173, v26
v_fmac_f32 v142, v174, v26
v_fmac_f32 v143, v175, v26
ds_write_b128 v8, v[140:143] offset:128
v_fmac_f32 v156, v188, v27
v_fmac_f32 v157, v189, v27
v_fmac_f32 v158, v190, v27
v_fmac_f32 v159, v191, v27
ds_write_b128 v8, v[156:159] offset:4224
s_waitcnt lgkmcnt(0)
s_barrier
ds_read_b128 v[192:195], v9 offset:0
ds_read_b128 v[196:199], v10 offset:0
ds_read_b128 v[200:203], v9 offset:16384
ds_read_b128 v[204:207], v10 offset:16384
ds_read_b128 v[208:211], v9 offset:32768
ds_read_b128 v[212:215], v10 offset:32768
ds_read_b128 v[216:219], v9 offset:49152
ds_read_b128 v[220:223], v10 offset:49152
s_waitcnt lgkmcnt(4)
v_add_f32 v192, v192, v200
v_add_f32 v193, v193, v201
v_add_f32 v194, v194, v202
v_add_f32 v195, v195, v203
v_add_f32 v196, v196, v204
v_add_f32 v197, v197, v205
v_add_f32 v198, v198, v206
v_add_f32 v199, v199, v207
s_waitcnt lgkmcnt(0)
v_add_f32 v208, v208, v216
v_add_f32 v209, v209, v217
v_add_f32 v210, v210, v218
v_add_f32 v211, v211, v219
v_add_f32 v212, v212, v220
v_add_f32 v213, v213, v221
v_add_f32 v214, v214, v222
v_add_f32 v215, v215, v223
v_add_f32 v192, v192, v208
v_add_f32 v193, v193, v209
v_add_f32 v194, v194, v210
v_add_f32 v195, v195, v211
v_add_f32 v196, v196, v212
v_add_f32 v197, v197, v213
v_add_f32 v198, v198, v214
v_add_f32 v199, v199, v215
v_cvt_pk_bf16_f32 v192, v192, v193
v_cvt_pk_bf16_f32 v193, v194, v195
v_cvt_pk_bf16_f32 v194, v196, v197
v_cvt_pk_bf16_f32 v195, v198, v199
buffer_store_dwordx4 v[192:195], v30, s[28:31], s53 offen sc1
s_endpgm
LT2:
s_waitcnt vmcnt(4)
s_barrier
ds_read_b128 v[128:131], v7 offset:0
ds_read_b64_tr_b16 v[40:41], v9 offset:2048
ds_read_b64_tr_b16 v[42:43], v9 offset:10240
ds_read_b128 v[132:135], v7 offset:4096
ds_read_b64_tr_b16 v[44:45], v10 offset:2048
ds_read_b64_tr_b16 v[46:47], v10 offset:10240
ds_read_b64_tr_b16 v[48:49], v9 offset:3072
ds_read_b64_tr_b16 v[50:51], v9 offset:11264
ds_read_b64_tr_b16 v[52:53], v10 offset:3072
ds_read_b64_tr_b16 v[54:55], v10 offset:11264
s_waitcnt lgkmcnt(7)
v_mfma_f32_16x16x32_bf16 v[96:99], v[40:43], v[128:131], 0
ds_read_b128 v[136:139], v8 offset:0
ds_read_b64_tr_b16 v[56:57], v9 offset:18432
s_add_u32 m0, s48, 65536
s_bfe_u32 s52, s47, 262152
s_add_u32 s52, s52, s89
s_and_b32 s52, s52, 7
s_lshl_b32 s93, s52, 7
s_add_u32 s93, s93, s49
buffer_load_dwordx4 v2, s[4:7], s93 offen offset:0 lds
s_waitcnt lgkmcnt(8)
v_mfma_f32_16x16x32_bf16 v[100:103], v[40:43], v[132:135], 0
ds_read_b64_tr_b16 v[58:59], v9 offset:26624
ds_read_b128 v[140:143], v8 offset:4096
s_waitcnt lgkmcnt(8)
v_mfma_f32_16x16x32_bf16 v[104:107], v[44:47], v[128:131], 0
ds_read_b64_tr_b16 v[60:61], v10 offset:18432
ds_read_b64_tr_b16 v[62:63], v10 offset:26624
s_mul_i32 s94, s52, s3
s_add_u32 s94, s94, s50
buffer_load_dwordx4 v4, s[8:11], s94 offen offset:2048 lds
v_mfma_f32_16x16x32_bf16 v[108:111], v[44:47], v[132:135], 0
ds_read_b64_tr_b16 v[64:65], v9 offset:19456
ds_read_b64_tr_b16 v[66:67], v9 offset:27648
s_waitcnt lgkmcnt(10)
v_mfma_f32_16x16x32_bf16 v[112:115], v[48:51], v[128:131], 0
ds_read_b64_tr_b16 v[68:69], v10 offset:19456
ds_read_b64_tr_b16 v[70:71], v10 offset:27648
buffer_load_dwordx4 v3, s[4:7], s93 offen offset:1024 lds
v_mfma_f32_16x16x32_bf16 v[116:119], v[48:51], v[132:135], 0
s_waitcnt lgkmcnt(10)
v_mfma_f32_16x16x32_bf16 v[120:123], v[52:55], v[128:131], 0
buffer_load_dwordx4 v5, s[8:11], s94 offen offset:3072 lds
v_mfma_f32_16x16x32_bf16 v[124:127], v[52:55], v[132:135], 0
s_waitcnt vmcnt(4) lgkmcnt(0)
s_barrier
s_cmp_lg_u32 s2, 64
s_cbranch_scc1 Lnp22
s_cmp_lg_u32 s40, 7
s_cbranch_scc1 Lnp22
s_mov_b32 s53, 0
Lnpl23:
s_add_u32 s53, s53, 1
s_mov_b64 s[54:55], 0
v_cmp_eq_u32 vcc, s53, v240
s_nop 0
s_or_b64 s[54:55], s[54:55], vcc
v_cmp_eq_u32 vcc, s53, v241
s_nop 0
s_or_b64 s[54:55], s[54:55], vcc
v_cmp_eq_u32 vcc, s53, v242
s_nop 0
s_or_b64 s[54:55], s[54:55], vcc
v_cmp_eq_u32 vcc, s53, v243
s_nop 0
s_or_b64 s[54:55], s[54:55], vcc
v_cmp_eq_u32 vcc, s53, v244
s_nop 0
s_or_b64 s[54:55], s[54:55], vcc
v_cmp_eq_u32 vcc, s53, v245
s_nop 0
s_or_b64 s[54:55], s[54:55], vcc
v_cmp_eq_u32 vcc, s53, v246
s_nop 0
s_or_b64 s[54:55], s[54:55], vcc
v_cmp_eq_u32 vcc, s53, v247
s_nop 0
s_or_b64 s[54:55], s[54:55], vcc
v_cmp_eq_u32 vcc, s53, v248
s_nop 0
s_or_b64 s[54:55], s[54:55], vcc
v_cmp_eq_u32 vcc, s53, v249
s_nop 0
s_or_b64 s[54:55], s[54:55], vcc
v_cmp_eq_u32 vcc, s53, v250
s_nop 0
s_or_b64 s[54:55], s[54:55], vcc
v_cmp_eq_u32 vcc, s53, v251
s_nop 0
s_or_b64 s[54:55], s[54:55], vcc
v_cmp_eq_u32 vcc, s53, v252
s_nop 0
s_or_b64 s[54:55], s[54:55], vcc
v_cmp_eq_u32 vcc, s53, v253
s_nop 0
s_or_b64 s[54:55], s[54:55], vcc
v_cmp_eq_u32 vcc, s53, v254
s_nop 0
s_or_b64 s[54:55], s[54:55], vcc
v_cmp_eq_u32 vcc, s53, v255
s_nop 0
s_or_b64 s[54:55], s[54:55], vcc
s_cbranch_scc1 Lnpl23
v_mov_b32 v31, s53
v_mov_b32 v32, 2147483648
v_writelane_b32 v32, 0, 0
buffer_store_dword v31, v32, s[32:35], 0 offen sc1
Lnp22:
v_mfma_f32_16x16x32_bf16 v[96:99], v[56:59], v[136:139], v[96:99]
ds_read_b128 v[144:147], v7 offset:32768
ds_read_b64_tr_b16 v[40:41], v9 offset:34816
s_add_u32 m0, s48, 98304
s_bfe_u32 s52, s47, 262156
s_add_u32 s52, s52, s89
s_and_b32 s52, s52, 7
s_lshl_b32 s93, s52, 7
s_add_u32 s93, s93, s49
buffer_load_dwordx4 v2, s[4:7], s93 offen offset:0 lds
v_mfma_f32_16x16x32_bf16 v[100:103], v[56:59], v[140:143], v[100:103]
ds_read_b64_tr_b16 v[42:43], v9 offset:43008
ds_read_b128 v[148:151], v7 offset:36864
v_mfma_f32_16x16x32_bf16 v[104:107], v[60:63], v[136:139], v[104:107]
ds_read_b64_tr_b16 v[44:45], v10 offset:34816
ds_read_b64_tr_b16 v[46:47], v10 offset:43008
v_mfma_f32_16x16x32_bf16 v[108:111], v[60:63], v[140:143], v[108:111]
ds_read_b64_tr_b16 v[48:49], v9 offset:35840
ds_read_b64_tr_b16 v[50:51], v9 offset:44032
v_mfma_f32_16x16x32_bf16 v[112:115], v[64:67], v[136:139], v[112:115]
ds_read_b64_tr_b16 v[52:53], v10 offset:35840
ds_read_b64_tr_b16 v[54:55], v10 offset:44032
s_mul_i32 s94, s52, s3
s_add_u32 s94, s94, s50
buffer_load_dwordx4 v4, s[8:11], s94 offen offset:2048 lds
v_mfma_f32_16x16x32_bf16 v[116:119], v[64:67], v[140:143], v[116:119]
v_mfma_f32_16x16x32_bf16 v[120:123], v[68:71], v[136:139], v[120:123]
v_mfma_f32_16x16x32_bf16 v[124:127], v[68:71], v[140:143], v[124:127]
s_waitcnt lgkmcnt(7)
v_mfma_f32_16x16x32_bf16 v[96:99], v[40:43], v[144:147], v[96:99]
ds_read_b128 v[152:155], v8 offset:32768
ds_read_b64_tr_b16 v[56:57], v9 offset:51200
buffer_load_dwordx4 v3, s[4:7], s93 offen offset:1024 lds
s_waitcnt lgkmcnt(8)
v_mfma_f32_16x16x32_bf16 v[100:103], v[40:43], v[148:151], v[100:103]
ds_read_b64_tr_b16 v[58:59], v9 offset:59392
ds_read_b128 v[156:159], v8 offset:36864
s_waitcnt lgkmcnt(8)
v_mfma_f32_16x16x32_bf16 v[104:107], v[44:47], v[144:147], v[104:107]
ds_read_b64_tr_b16 v[60:61], v10 offset:51200
ds_read_b64_tr_b16 v[62:63], v10 offset:59392
v_mfma_f32_16x16x32_bf16 v[108:111], v[44:47], v[148:151], v[108:111]
ds_read_b64_tr_b16 v[64:65], v9 offset:52224
ds_read_b64_tr_b16 v[66:67], v9 offset:60416
s_waitcnt lgkmcnt(10)
v_mfma_f32_16x16x32_bf16 v[112:115], v[48:51], v[144:147], v[112:115]
ds_read_b64_tr_b16 v[68:69], v10 offset:52224
ds_read_b64_tr_b16 v[70:71], v10 offset:60416
buffer_load_dwordx4 v5, s[8:11], s94 offen offset:3072 lds
v_mfma_f32_16x16x32_bf16 v[116:119], v[48:51], v[148:151], v[116:119]
s_waitcnt lgkmcnt(10)
v_mfma_f32_16x16x32_bf16 v[120:123], v[52:55], v[144:147], v[120:123]
v_mfma_f32_16x16x32_bf16 v[124:127], v[52:55], v[148:151], v[124:127]
s_waitcnt lgkmcnt(7)
v_mfma_f32_16x16x32_bf16 v[96:99], v[56:59], v[152:155], v[96:99]
s_waitcnt lgkmcnt(6)
v_mfma_f32_16x16x32_bf16 v[100:103], v[56:59], v[156:159], v[100:103]
s_waitcnt lgkmcnt(4)
v_mfma_f32_16x16x32_bf16 v[104:107], v[60:63], v[152:155], v[104:107]
v_mfma_f32_16x16x32_bf16 v[108:111], v[60:63], v[156:159], v[108:111]
s_waitcnt lgkmcnt(2)
v_mfma_f32_16x16x32_bf16 v[112:115], v[64:67], v[152:155], v[112:115]
v_mfma_f32_16x16x32_bf16 v[116:119], v[64:67], v[156:159], v[116:119]
s_waitcnt lgkmcnt(0)
v_mfma_f32_16x16x32_bf16 v[120:123], v[68:71], v[152:155], v[120:123]
v_mfma_f32_16x16x32_bf16 v[124:127], v[68:71], v[156:159], v[124:127]
s_waitcnt vmcnt(4)
s_barrier
v_xor_b32 v7, 65536, v7
v_xor_b32 v8, 65536, v8
v_xor_b32 v9, 65536, v9
v_xor_b32 v10, 65536, v10
s_lshr_b32 s53, s2, 3
s_and_b32 s53, s53, 7
s_cmp_lg_u32 s53, 0
s_cbranch_scc1 Ltc24z
s_sub_u32 s53, s2, 0
s_and_b32 s53, s53, 255
s_cmp_ge_u32 s53, 256
s_cbranch_scc1 Ltc24z
s_cmp_ge_u32 s40, 1
s_cbranch_scc1 Ltc24w0
s_mul_i32 s54, s53, 1
s_add_u32 s54, s54, s40
s_mul_i32 s54, s54, 7168
s_add_u32 s54, s54, 4096
v_cmp_gt_u32 vcc, 56, v1
v_lshlrev_b32 v31, 7, v1
v_mov_b32 v32, 2147483648
v_cndmask_b32 v31, v32, v31, vcc
buffer_load_dword v0, v31, s[20:23], s54 offen
Ltc24w0:
s_cmp_lg_u32 s40, 1
s_cbranch_scc1 Ltc24w1
s_mul_i32 s54, s53, 2048
s_add_u32 s54, s54, 4096
v_cmp_gt_u32 vcc, 16, v1
v_lshlrev_b32 v31, 7, v1
v_mov_b32 v32, 2147483648
v_cndmask_b32 v31, v32, v31, vcc
buffer_load_dword v0, v31, s[16:19], s54 offen
Ltc24w1:
Ltc24z:
ds_read_b128 v[160:163], v7 offset:0
ds_read_b64_tr_b16 v[40:41], v9 offset:2048
ds_read_b64_tr_b16 v[42:43], v9 offset:10240
ds_read_b128 v[164:167], v7 offset:4096
ds_read_b64_tr_b16 v[44:45], v10 offset:2048
ds_read_b64_tr_b16 v[46:47], v10 offset:10240
ds_read_b64_tr_b16 v[48:49], v9 offset:3072
ds_read_b64_tr_b16 v[50:51], v9 offset:11264
ds_read_b64_tr_b16 v[52:53], v10 offset:3072
ds_read_b64_tr_b16 v[54:55], v10 offset:11264
s_lshr_b32 s53, s2, 3
s_and_b32 s53, s53, 7
s_cmp_lg_u32 s53, 1
s_cbranch_scc1 Ltc25z
s_sub_u32 s53, s2, 0
s_and_b32 s53, s53, 255
s_cmp_ge_u32 s53, 256
s_cbranch_scc1 Ltc25z
s_cmp_ge_u32 s40, 1
s_cbranch_scc1 Ltc25w0
s_mul_i32 s54, s53, 1
s_add_u32 s54, s54, s40
s_mul_i32 s54, s54, 7168
s_add_u32 s54, s54, 4096
v_cmp_gt_u32 vcc, 56, v1
v_lshlrev_b32 v31, 7, v1
v_mov_b32 v32, 2147483648
v_cndmask_b32 v31, v32, v31, vcc
buffer_load_dword v0, v31, s[20:23], s54 offen
Ltc25w0:
s_cmp_lg_u32 s40, 1
s_cbranch_scc1 Ltc25w1
s_mul_i32 s54, s53, 2048
s_add_u32 s54, s54, 4096
v_cmp_gt_u32 vcc, 16, v1
v_lshlrev_b32 v31, 7, v1
v_mov_b32 v32, 2147483648
v_cndmask_b32 v31, v32, v31, vcc
buffer_load_dword v0, v31, s[16:19], s54 offen
Ltc25w1:
Ltc25z:
s_waitcnt lgkmcnt(7)
v_mfma_f32_16x16x32_bf16 v[96:99], v[40:43], v[160:163], v[96:99]
ds_read_b128 v[168:171], v8 offset:0
ds_read_b64_tr_b16 v[56:57], v9 offset:18432
s_add_u32 m0, s48, 0
s_bfe_u32 s52, s47, 262160
s_add_u32 s52, s52, s89
s_and_b32 s52, s52, 7
s_lshl_b32 s93, s52, 7
s_add_u32 s93, s93, s49
buffer_load_dwordx4 v2, s[4:7], s93 offen offset:0 lds
s_waitcnt lgkmcnt(8)
v_mfma_f32_16x16x32_bf16 v[100:103], v[40:43], v[164:167], v[100:103]
ds_read_b64_tr_b16 v[58:59], v9 offset:26624
ds_read_b128 v[172:175], v8 offset:4096
s_mul_i32 s94, s52, s3
s_add_u32 s94, s94, s50
buffer_load_dwordx4 v4, s[8:11], s94 offen offset:2048 lds
s_waitcnt lgkmcnt(8)
v_mfma_f32_16x16x32_bf16 v[104:107], v[44:47], v[160:163], v[104:107]
ds_read_b64_tr_b16 v[60:61], v10 offset:18432
ds_read_b64_tr_b16 v[62:63], v10 offset:26624
buffer_load_dwordx4 v3, s[4:7], s93 offen offset:1024 lds
v_mfma_f32_16x16x32_bf16 v[108:111], v[44:47], v[164:167], v[108:111]
ds_read_b64_tr_b16 v[64:65], v9 offset:19456
ds_read_b64_tr_b16 v[66:67], v9 offset:27648
buffer_load_dwordx4 v5, s[8:11], s94 offen offset:3072 lds
s_waitcnt lgkmcnt(10)
v_mfma_f32_16x16x32_bf16 v[112:115], v[48:51], v[160:163], v[112:115]
ds_read_b64_tr_b16 v[68:69], v10 offset:19456
ds_read_b64_tr_b16 v[70:71], v10 offset:27648
s_add_u32 m0, s48, 32768
s_bfe_u32 s52, s47, 262164
s_add_u32 s52, s52, s89
s_and_b32 s52, s52, 7
s_lshl_b32 s93, s52, 7
s_add_u32 s93, s93, s49
buffer_load_dwordx4 v2, s[4:7], s93 offen offset:0 lds
v_mfma_f32_16x16x32_bf16 v[116:119], v[48:51], v[164:167], v[116:119]
s_mul_i32 s94, s52, s3
s_add_u32 s94, s94, s50
buffer_load_dwordx4 v4, s[8:11], s94 offen offset:2048 lds
s_waitcnt lgkmcnt(10)
v_mfma_f32_16x16x32_bf16 v[120:123], v[52:55], v[160:163], v[120:123]
buffer_load_dwordx4 v3, s[4:7], s93 offen offset:1024 lds
v_mfma_f32_16x16x32_bf16 v[124:127], v[52:55], v[164:167], v[124:127]
buffer_load_dwordx4 v5, s[8:11], s94 offen offset:3072 lds
s_waitcnt lgkmcnt(7)
v_mfma_f32_16x16x32_bf16 v[96:99], v[56:59], v[168:171], v[96:99]
s_waitcnt lgkmcnt(6)
v_mfma_f32_16x16x32_bf16 v[100:103], v[56:59], v[172:175], v[100:103]
s_waitcnt lgkmcnt(4)
v_mfma_f32_16x16x32_bf16 v[104:107], v[60:63], v[168:171], v[104:107]
v_mfma_f32_16x16x32_bf16 v[108:111], v[60:63], v[172:175], v[108:111]
s_waitcnt lgkmcnt(2)
v_mfma_f32_16x16x32_bf16 v[112:115], v[64:67], v[168:171], v[112:115]
v_mfma_f32_16x16x32_bf16 v[116:119], v[64:67], v[172:175], v[116:119]
s_waitcnt lgkmcnt(0)
v_mfma_f32_16x16x32_bf16 v[120:123], v[68:71], v[168:171], v[120:123]
v_mfma_f32_16x16x32_bf16 v[124:127], v[68:71], v[172:175], v[124:127]
s_waitcnt vmcnt(8)
s_barrier
s_lshr_b32 s53, s2, 3
s_and_b32 s53, s53, 7
s_cmp_lg_u32 s53, 2
s_cbranch_scc1 Ltc26z
s_sub_u32 s53, s2, 0
s_and_b32 s53, s53, 255
s_cmp_ge_u32 s53, 256
s_cbranch_scc1 Ltc26z
s_cmp_ge_u32 s40, 1
s_cbranch_scc1 Ltc26w0
s_mul_i32 s54, s53, 1
s_add_u32 s54, s54, s40
s_mul_i32 s54, s54, 7168
s_add_u32 s54, s54, 4096
v_cmp_gt_u32 vcc, 56, v1
v_lshlrev_b32 v31, 7, v1
v_mov_b32 v32, 2147483648
v_cndmask_b32 v31, v32, v31, vcc
buffer_load_dword v0, v31, s[20:23], s54 offen
Ltc26w0:
s_cmp_lg_u32 s40, 1
s_cbranch_scc1 Ltc26w1
s_mul_i32 s54, s53, 2048
s_add_u32 s54, s54, 4096
v_cmp_gt_u32 vcc, 16, v1
v_lshlrev_b32 v31, 7, v1
v_mov_b32 v32, 2147483648
v_cndmask_b32 v31, v32, v31, vcc
buffer_load_dword v0, v31, s[16:19], s54 offen
Ltc26w1:
Ltc26z:
ds_read_b128 v[176:179], v7 offset:32768
ds_read_b64_tr_b16 v[40:41], v9 offset:34816
ds_read_b64_tr_b16 v[42:43], v9 offset:43008
ds_read_b128 v[180:183], v7 offset:36864
ds_read_b64_tr_b16 v[44:45], v10 offset:34816
ds_read_b64_tr_b16 v[46:47], v10 offset:43008
ds_read_b64_tr_b16 v[48:49], v9 offset:35840
ds_read_b64_tr_b16 v[50:51], v9 offset:44032
ds_read_b64_tr_b16 v[52:53], v10 offset:35840
ds_read_b64_tr_b16 v[54:55], v10 offset:44032
s_lshr_b32 s53, s2, 3
s_and_b32 s53, s53, 7
s_cmp_lg_u32 s53, 3
s_cbranch_scc1 Ltc27z
s_sub_u32 s53, s2, 0
s_and_b32 s53, s53, 255
s_cmp_ge_u32 s53, 256
s_cbranch_scc1 Ltc27z
s_cmp_ge_u32 s40, 1
s_cbranch_scc1 Ltc27w0
s_mul_i32 s54, s53, 1
s_add_u32 s54, s54, s40
s_mul_i32 s54, s54, 7168
s_add_u32 s54, s54, 4096
v_cmp_gt_u32 vcc, 56, v1
v_lshlrev_b32 v31, 7, v1
v_mov_b32 v32, 2147483648
v_cndmask_b32 v31, v32, v31, vcc
buffer_load_dword v0, v31, s[20:23], s54 offen
Ltc27w0:
s_cmp_lg_u32 s40, 1
s_cbranch_scc1 Ltc27w1
s_mul_i32 s54, s53, 2048
s_add_u32 s54, s54, 4096
v_cmp_gt_u32 vcc, 16, v1
v_lshlrev_b32 v31, 7, v1
v_mov_b32 v32, 2147483648
v_cndmask_b32 v31, v32, v31, vcc
buffer_load_dword v0, v31, s[16:19], s54 offen
Ltc27w1:
Ltc27z:
s_waitcnt lgkmcnt(7)
v_mfma_f32_16x16x32_bf16 v[96:99], v[40:43], v[176:179], v[96:99]
ds_read_b128 v[184:187], v8 offset:32768
ds_read_b64_tr_b16 v[56:57], v9 offset:51200
s_add_u32 m0, s48, 65536
s_bfe_u32 s52, s47, 262168
s_add_u32 s52, s52, s89
s_and_b32 s52, s52, 7
s_lshl_b32 s93, s52, 7
s_add_u32 s93, s93, s49
buffer_load_dwordx4 v2, s[4:7], s93 offen offset:0 lds
s_waitcnt lgkmcnt(8)
v_mfma_f32_16x16x32_bf16 v[100:103], v[40:43], v[180:183], v[100:103]
ds_read_b64_tr_b16 v[58:59], v9 offset:59392
ds_read_b128 v[188:191], v8 offset:36864
s_waitcnt lgkmcnt(8)
v_mfma_f32_16x16x32_bf16 v[104:107], v[44:47], v[176:179], v[104:107]
ds_read_b64_tr_b16 v[60:61], v10 offset:51200
ds_read_b64_tr_b16 v[62:63], v10 offset:59392
s_mul_i32 s94, s52, s3
s_add_u32 s94, s94, s50
buffer_load_dwordx4 v4, s[8:11], s94 offen offset:2048 lds
v_mfma_f32_16x16x32_bf16 v[108:111], v[44:47], v[180:183], v[108:111]
ds_read_b64_tr_b16 v[64:65], v9 offset:52224
ds_read_b64_tr_b16 v[66:67], v9 offset:60416
s_waitcnt lgkmcnt(10)
v_mfma_f32_16x16x32_bf16 v[112:115], v[48:51], v[176:179], v[112:115]
ds_read_b64_tr_b16 v[68:69], v10 offset:52224
ds_read_b64_tr_b16 v[70:71], v10 offset:60416
buffer_load_dwordx4 v3, s[4:7], s93 offen offset:1024 lds
v_mfma_f32_16x16x32_bf16 v[116:119], v[48:51], v[180:183], v[116:119]
s_waitcnt lgkmcnt(10)
v_mfma_f32_16x16x32_bf16 v[120:123], v[52:55], v[176:179], v[120:123]
buffer_load_dwordx4 v5, s[8:11], s94 offen offset:3072 lds
v_mfma_f32_16x16x32_bf16 v[124:127], v[52:55], v[180:183], v[124:127]
s_waitcnt vmcnt(8) lgkmcnt(0)
s_barrier
v_xor_b32 v7, 65536, v7
v_xor_b32 v8, 65536, v8
v_xor_b32 v9, 65536, v9
v_xor_b32 v10, 65536, v10
s_sub_u32 s95, s60, s97
s_and_b32 s95, s95, 3
s_mov_b32 s70, 3703190032
s_mov_b32 s72, 9991764
s_mov_b32 s71, 12816
s_cmp_eq_u32 s95, 0
s_cselect_b32 s70, 3703181362, s70
s_cselect_b32 s72, 9983094, s72
s_cmp_eq_u32 s95, 1
s_cselect_b32 s70, 3694311952, s70
s_cselect_b32 s72, 7772244, s72
s_cmp_eq_u32 s95, 2
s_cselect_b32 s70, 3134992912, s70
s_cmp_eq_u32 s95, 3
s_cselect_b32 s71, 4146, s71
s_mul_i32 s96, s41, 14336
s_add_u32 s74, s62, s96
s_add_u32 s74, s74, 16384
s_lshl_b32 s95, s41, 12
s_add_u32 s75, s62, s95
s_lshr_b32 s53, s2, 3
s_and_b32 s53, s53, 7
s_cmp_lg_u32 s53, 4
s_cbranch_scc1 Ltc28z
s_sub_u32 s53, s2, 0
s_and_b32 s53, s53, 255
s_cmp_ge_u32 s53, 256
s_cbranch_scc1 Ltc28z
s_cmp_ge_u32 s40, 1
s_cbranch_scc1 Ltc28w0
s_mul_i32 s54, s53, 1
s_add_u32 s54, s54, s40
s_mul_i32 s54, s54, 7168
s_add_u32 s54, s54, 4096
v_cmp_gt_u32 vcc, 56, v1
v_lshlrev_b32 v31, 7, v1
v_mov_b32 v32, 2147483648
v_cndmask_b32 v31, v32, v31, vcc
buffer_load_dword v0, v31, s[20:23], s54 offen
Ltc28w0:
s_cmp_lg_u32 s40, 1
s_cbranch_scc1 Ltc28w1
s_mul_i32 s54, s53, 2048
s_add_u32 s54, s54, 4096
v_cmp_gt_u32 vcc, 16, v1
v_lshlrev_b32 v31, 7, v1
v_mov_b32 v32, 2147483648
v_cndmask_b32 v31, v32, v31, vcc
buffer_load_dword v0, v31, s[16:19], s54 offen
Ltc28w1:
Ltc28z:
v_mfma_f32_16x16x32_bf16 v[96:99], v[56:59], v[184:187], v[96:99]
ds_read_b128 v[192:195], v7 offset:0
ds_read_b64_tr_b16 v[40:41], v9 offset:2048
s_add_u32 m0, s48, 98304
s_bfe_u32 s52, s47, 262172
s_add_u32 s52, s52, s89
s_and_b32 s52, s52, 7
s_lshl_b32 s93, s52, 7
s_add_u32 s93, s93, s49
buffer_load_dwordx4 v2, s[4:7], s93 offen offset:0 lds
v_mfma_f32_16x16x32_bf16 v[100:103], v[56:59], v[188:191], v[100:103]
ds_read_b64_tr_b16 v[42:43], v9 offset:10240
ds_read_b128 v[196:199], v7 offset:4096
v_mfma_f32_16x16x32_bf16 v[104:107], v[60:63], v[184:187], v[104:107]
ds_read_b64_tr_b16 v[44:45], v10 offset:2048
ds_read_b64_tr_b16 v[46:47], v10 offset:10240
v_mfma_f32_16x16x32_bf16 v[108:111], v[60:63], v[188:191], v[108:111]
ds_read_b64_tr_b16 v[48:49], v9 offset:3072
ds_read_b64_tr_b16 v[50:51], v9 offset:11264
v_mfma_f32_16x16x32_bf16 v[112:115], v[64:67], v[184:187], v[112:115]
ds_read_b64_tr_b16 v[52:53], v10 offset:3072
ds_read_b64_tr_b16 v[54:55], v10 offset:11264
s_mul_i32 s94, s52, s3
s_add_u32 s94, s94, s50
buffer_load_dwordx4 v4, s[8:11], s94 offen offset:2048 lds
v_mfma_f32_16x16x32_bf16 v[116:119], v[64:67], v[188:191], v[116:119]
v_mfma_f32_16x16x32_bf16 v[120:123], v[68:71], v[184:187], v[120:123]
v_mfma_f32_16x16x32_bf16 v[124:127], v[68:71], v[188:191], v[124:127]
s_lshr_b32 s53, s2, 3
s_and_b32 s53, s53, 7
s_cmp_lg_u32 s53, 5
s_cbranch_scc1 Ltc29z
s_sub_u32 s53, s2, 0
s_and_b32 s53, s53, 255
s_cmp_ge_u32 s53, 256
s_cbranch_scc1 Ltc29z
s_cmp_ge_u32 s40, 1
s_cbranch_scc1 Ltc29w0
s_mul_i32 s54, s53, 1
s_add_u32 s54, s54, s40
s_mul_i32 s54, s54, 7168
s_add_u32 s54, s54, 4096
v_cmp_gt_u32 vcc, 56, v1
v_lshlrev_b32 v31, 7, v1
v_mov_b32 v32, 2147483648
v_cndmask_b32 v31, v32, v31, vcc
buffer_load_dword v0, v31, s[20:23], s54 offen
Ltc29w0:
s_cmp_lg_u32 s40, 1
s_cbranch_scc1 Ltc29w1
s_mul_i32 s54, s53, 2048
s_add_u32 s54, s54, 4096
v_cmp_gt_u32 vcc, 16, v1
v_lshlrev_b32 v31, 7, v1
v_mov_b32 v32, 2147483648
v_cndmask_b32 v31, v32, v31, vcc
buffer_load_dword v0, v31, s[16:19], s54 offen
Ltc29w1:
Ltc29z:
s_waitcnt lgkmcnt(7)
v_mfma_f32_16x16x32_bf16 v[96:99], v[40:43], v[192:195], v[96:99]
ds_read_b128 v[200:203], v8 offset:0
ds_read_b64_tr_b16 v[56:57], v9 offset:18432
buffer_load_dwordx4 v3, s[4:7], s93 offen offset:1024 lds
s_waitcnt lgkmcnt(8)
v_mfma_f32_16x16x32_bf16 v[100:103], v[40:43], v[196:199], v[100:103]
ds_read_b64_tr_b16 v[58:59], v9 offset:26624
ds_read_b128 v[204:207], v8 offset:4096
s_waitcnt lgkmcnt(8)
v_mfma_f32_16x16x32_bf16 v[104:107], v[44:47], v[192:195], v[104:107]
ds_read_b64_tr_b16 v[60:61], v10 offset:18432
ds_read_b64_tr_b16 v[62:63], v10 offset:26624
buffer_load_dwordx4 v5, s[8:11], s94 offen offset:3072 lds
v_mfma_f32_16x16x32_bf16 v[108:111], v[44:47], v[196:199], v[108:111]
ds_read_b64_tr_b16 v[64:65], v9 offset:19456
ds_read_b64_tr_b16 v[66:67], v9 offset:27648
s_waitcnt lgkmcnt(10)
v_mfma_f32_16x16x32_bf16 v[112:115], v[48:51], v[192:195], v[112:115]
ds_read_b64_tr_b16 v[68:69], v10 offset:19456
ds_read_b64_tr_b16 v[70:71], v10 offset:27648
v_mfma_f32_16x16x32_bf16 v[116:119], v[48:51], v[196:199], v[116:119]
buffer_load_dwordx4 v[88:91], v15, s[4:7], s78 offen
buffer_load_dwordx4 v[92:95], v15, s[36:39], 0 offen
s_waitcnt lgkmcnt(10)
v_mfma_f32_16x16x32_bf16 v[120:123], v[52:55], v[192:195], v[120:123]
v_mfma_f32_16x16x32_bf16 v[124:127], v[52:55], v[196:199], v[124:127]
s_waitcnt vmcnt(10) lgkmcnt(0)
s_barrier
s_lshl_b32 s96, s96, 5
s_add_u32 s76, s63, s96
s_lshl_b32 s95, s95, 5
s_add_u32 s77, s63, s95
s_mul_i32 s95, s45, 448
s_add_u32 s95, s95, 512
s_lshr_b32 s96, s44, 1
s_mul_i32 s96, s96, 10
s_add_u32 s96, s96, s42
s_lshl_b32 s96, s96, 5
s_add_u32 s96, s96, s95
s_lshl_b32 s96, s96, 5
s_add_u32 s83, s96, s57
s_and_b32 s96, s44, 2
v_lshlrev_b32 v33, 9, v33
v_sub_u32 v4, v4, v33
v_subrev_u32 v4, 1024, v4
s_lshr_b32 s53, s2, 3
s_and_b32 s53, s53, 7
s_cmp_lg_u32 s53, 6
s_cbranch_scc1 Ltc30z
s_sub_u32 s53, s2, 0
s_and_b32 s53, s53, 255
s_cmp_ge_u32 s53, 256
s_cbranch_scc1 Ltc30z
s_cmp_ge_u32 s40, 1
s_cbranch_scc1 Ltc30w0
s_mul_i32 s54, s53, 1
s_add_u32 s54, s54, s40
s_mul_i32 s54, s54, 7168
s_add_u32 s54, s54, 4096
v_cmp_gt_u32 vcc, 56, v1
v_lshlrev_b32 v31, 7, v1
v_mov_b32 v32, 2147483648
v_cndmask_b32 v31, v32, v31, vcc
buffer_load_dword v0, v31, s[20:23], s54 offen
Ltc30w0:
s_cmp_lg_u32 s40, 1
s_cbranch_scc1 Ltc30w1
s_mul_i32 s54, s53, 2048
s_add_u32 s54, s54, 4096
v_cmp_gt_u32 vcc, 16, v1
v_lshlrev_b32 v31, 7, v1
v_mov_b32 v32, 2147483648
v_cndmask_b32 v31, v32, v31, vcc
buffer_load_dword v0, v31, s[16:19], s54 offen
Ltc30w1:
Ltc30z:
v_mfma_f32_16x16x32_bf16 v[96:99], v[56:59], v[200:203], v[96:99]
ds_read_b128 v[208:211], v7 offset:32768
ds_read_b64_tr_b16 v[40:41], v9 offset:34816
s_add_u32 m0, s48, 0
s_bfe_u32 s52, s47, 262144
s_add_u32 s52, s52, s89
s_and_b32 s52, s52, 7
s_mul_i32 s94, s52, 196608
s_add_u32 s94, s94, s51
buffer_load_dwordx4 v4, s[12:15], s94 offen offset:0 lds
v_mfma_f32_16x16x32_bf16 v[100:103], v[56:59], v[204:207], v[100:103]
ds_read_b64_tr_b16 v[42:43], v9 offset:43008
ds_read_b128 v[212:215], v7 offset:36864
v_mfma_f32_16x16x32_bf16 v[104:107], v[60:63], v[200:203], v[104:107]
ds_read_b64_tr_b16 v[44:45], v10 offset:34816
ds_read_b64_tr_b16 v[46:47], v10 offset:43008
v_mfma_f32_16x16x32_bf16 v[108:111], v[60:63], v[204:207], v[108:111]
ds_read_b64_tr_b16 v[48:49], v9 offset:35840
ds_read_b64_tr_b16 v[50:51], v9 offset:44032
v_mfma_f32_16x16x32_bf16 v[112:115], v[64:67], v[200:203], v[112:115]
ds_read_b64_tr_b16 v[52:53], v10 offset:35840
ds_read_b64_tr_b16 v[54:55], v10 offset:44032
s_bfe_u32 s52, s47, 262148
s_add_u32 s52, s52, s89
s_and_b32 s52, s52, 7
s_mul_i32 s94, s52, 196608
s_add_u32 s94, s94, s51
s_sub_u32 s94, s94, 1024
buffer_load_dwordx4 v4, s[12:15], s94 offen offset:1024 lds
v_mfma_f32_16x16x32_bf16 v[116:119], v[64:67], v[204:207], v[116:119]
v_mfma_f32_16x16x32_bf16 v[120:123], v[68:71], v[200:203], v[120:123]
v_mfma_f32_16x16x32_bf16 v[124:127], v[68:71], v[204:207], v[124:127]
s_lshr_b32 s53, s2, 3
s_and_b32 s53, s53, 7
s_cmp_lg_u32 s53, 7
s_cbranch_scc1 Ltc31z
s_sub_u32 s53, s2, 0
s_and_b32 s53, s53, 255
s_cmp_ge_u32 s53, 256
s_cbranch_scc1 Ltc31z
s_cmp_ge_u32 s40, 1
s_cbranch_scc1 Ltc31w0
s_mul_i32 s54, s53, 1
s_add_u32 s54, s54, s40
s_mul_i32 s54, s54, 7168
s_add_u32 s54, s54, 4096
v_cmp_gt_u32 vcc, 56, v1
v_lshlrev_b32 v31, 7, v1
v_mov_b32 v32, 2147483648
v_cndmask_b32 v31, v32, v31, vcc
buffer_load_dword v0, v31, s[20:23], s54 offen
Ltc31w0:
s_cmp_lg_u32 s40, 1
s_cbranch_scc1 Ltc31w1
s_mul_i32 s54, s53, 2048
s_add_u32 s54, s54, 4096
v_cmp_gt_u32 vcc, 16, v1
v_lshlrev_b32 v31, 7, v1
v_mov_b32 v32, 2147483648
v_cndmask_b32 v31, v32, v31, vcc
buffer_load_dword v0, v31, s[16:19], s54 offen
Ltc31w1:
Ltc31z:
s_waitcnt lgkmcnt(7)
v_mfma_f32_16x16x32_bf16 v[96:99], v[40:43], v[208:211], v[96:99]
ds_read_b128 v[216:219], v8 offset:32768
ds_read_b64_tr_b16 v[56:57], v9 offset:51200
s_bfe_u32 s52, s47, 262152
s_add_u32 s52, s52, s89
s_and_b32 s52, s52, 7
s_mul_i32 s94, s52, 196608
s_add_u32 s94, s94, s51
s_sub_u32 s94, s94, 2048
buffer_load_dwordx4 v4, s[12:15], s94 offen offset:2048 lds
s_waitcnt lgkmcnt(8)
v_mfma_f32_16x16x32_bf16 v[100:103], v[40:43], v[212:215], v[100:103]
ds_read_b64_tr_b16 v[58:59], v9 offset:59392
ds_read_b128 v[220:223], v8 offset:36864
s_waitcnt lgkmcnt(8)
v_mfma_f32_16x16x32_bf16 v[104:107], v[44:47], v[208:211], v[104:107]
ds_read_b64_tr_b16 v[60:61], v10 offset:51200
ds_read_b64_tr_b16 v[62:63], v10 offset:59392
v_mfma_f32_16x16x32_bf16 v[108:111], v[44:47], v[212:215], v[108:111]
ds_read_b64_tr_b16 v[64:65], v9 offset:52224
ds_read_b64_tr_b16 v[66:67], v9 offset:60416
s_waitcnt lgkmcnt(10)
v_mfma_f32_16x16x32_bf16 v[112:115], v[48:51], v[208:211], v[112:115]
ds_read_b64_tr_b16 v[68:69], v10 offset:52224
ds_read_b64_tr_b16 v[70:71], v10 offset:60416
s_bfe_u32 s52, s47, 262156
s_add_u32 s52, s52, s89
s_and_b32 s52, s52, 7
s_mul_i32 s94, s52, 196608
s_add_u32 s94, s94, s51
s_sub_u32 s94, s94, 3072
buffer_load_dwordx4 v4, s[12:15], s94 offen offset:3072 lds
v_mfma_f32_16x16x32_bf16 v[116:119], v[48:51], v[212:215], v[116:119]
s_waitcnt lgkmcnt(10)
v_mfma_f32_16x16x32_bf16 v[120:123], v[52:55], v[208:211], v[120:123]
v_mfma_f32_16x16x32_bf16 v[124:127], v[52:55], v[212:215], v[124:127]
s_waitcnt vmcnt(10) lgkmcnt(0)
s_barrier
v_xor_b32 v7, 65536, v7
v_xor_b32 v8, 65536, v8
v_xor_b32 v9, 65536, v9
v_xor_b32 v10, 65536, v10
s_add_u32 s96, s96, s42
s_add_u32 s96, s96, 12
s_lshl4_add_u32 s95, s96, s95
s_lshl_b32 s95, s95, 5
s_add_u32 s87, s95, s57
s_lshl3_add_u32 s95, s46, s40
s_lshl_b32 s95, s95, 12
s_add_u32 s84, s95, 131072
s_lshl1_add_u32 s95, s46, s42
s_lshl_b32 s96, s95, 11
s_add_u32 s85, s96, 655360
s_lshl_b32 s95, s95, 10
s_add_u32 s86, s95, s57
s_lshl_b32 s95, s42, 10
s_add_u32 s79, s95, 131072
v_mfma_f32_16x16x32_bf16 v[96:99], v[56:59], v[216:219], v[96:99]
ds_read_b128 v[224:227], v7 offset:0
ds_read_b64_tr_b16 v[40:41], v9 offset:2048
s_add_u32 m0, s48, 32768
s_bfe_u32 s52, s47, 262160
s_add_u32 s52, s52, s89
s_and_b32 s52, s52, 7
s_mul_i32 s94, s52, 196608
s_add_u32 s94, s94, s51
buffer_load_dwordx4 v4, s[12:15], s94 offen offset:0 lds
v_mfma_f32_16x16x32_bf16 v[100:103], v[56:59], v[220:223], v[100:103]
ds_read_b64_tr_b16 v[42:43], v9 offset:10240
ds_read_b128 v[228:231], v7 offset:4096
v_mfma_f32_16x16x32_bf16 v[104:107], v[60:63], v[216:219], v[104:107]
ds_read_b64_tr_b16 v[44:45], v10 offset:2048
ds_read_b64_tr_b16 v[46:47], v10 offset:10240
v_mfma_f32_16x16x32_bf16 v[108:111], v[60:63], v[220:223], v[108:111]
ds_read_b64_tr_b16 v[48:49], v9 offset:3072
ds_read_b64_tr_b16 v[50:51], v9 offset:11264
v_mfma_f32_16x16x32_bf16 v[112:115], v[64:67], v[216:219], v[112:115]
ds_read_b64_tr_b16 v[52:53], v10 offset:3072
ds_read_b64_tr_b16 v[54:55], v10 offset:11264
s_bfe_u32 s52, s47, 262164
s_add_u32 s52, s52, s89
s_and_b32 s52, s52, 7
s_mul_i32 s94, s52, 196608
s_add_u32 s94, s94, s51
s_sub_u32 s94, s94, 1024
buffer_load_dwordx4 v4, s[12:15], s94 offen offset:1024 lds
v_mfma_f32_16x16x32_bf16 v[116:119], v[64:67], v[220:223], v[116:119]
v_mfma_f32_16x16x32_bf16 v[120:123], v[68:71], v[216:219], v[120:123]
v_mfma_f32_16x16x32_bf16 v[124:127], v[68:71], v[220:223], v[124:127]
v_mov_b32 v35, 0
buffer_load_dword v34, v35, s[32:35], 0 offen sc1
s_waitcnt lgkmcnt(7)
v_mfma_f32_16x16x32_bf16 v[96:99], v[40:43], v[224:227], v[96:99]
ds_read_b128 v[232:235], v8 offset:0
ds_read_b64_tr_b16 v[56:57], v9 offset:18432
s_bfe_u32 s52, s47, 262168
s_add_u32 s52, s52, s89
s_and_b32 s52, s52, 7
s_mul_i32 s94, s52, 196608
s_add_u32 s94, s94, s51
s_sub_u32 s94, s94, 2048
buffer_load_dwordx4 v4, s[12:15], s94 offen offset:2048 lds
s_waitcnt lgkmcnt(8)
v_mfma_f32_16x16x32_bf16 v[100:103], v[40:43], v[228:231], v[100:103]
ds_read_b64_tr_b16 v[58:59], v9 offset:26624
ds_read_b128 v[236:239], v8 offset:4096
s_waitcnt lgkmcnt(8)
v_mfma_f32_16x16x32_bf16 v[104:107], v[44:47], v[224:227], v[104:107]
ds_read_b64_tr_b16 v[60:61], v10 offset:18432
ds_read_b64_tr_b16 v[62:63], v10 offset:26624
v_mfma_f32_16x16x32_bf16 v[108:111], v[44:47], v[228:231], v[108:111]
ds_read_b64_tr_b16 v[64:65], v9 offset:19456
ds_read_b64_tr_b16 v[66:67], v9 offset:27648
s_waitcnt lgkmcnt(10)
v_mfma_f32_16x16x32_bf16 v[112:115], v[48:51], v[224:227], v[112:115]
ds_read_b64_tr_b16 v[68:69], v10 offset:19456
ds_read_b64_tr_b16 v[70:71], v10 offset:27648
s_bfe_u32 s52, s47, 262172
s_add_u32 s52, s52, s89
s_and_b32 s52, s52, 7
s_mul_i32 s94, s52, 196608
s_add_u32 s94, s94, s51
s_sub_u32 s94, s94, 3072
buffer_load_dwordx4 v4, s[12:15], s94 offen offset:3072 lds
v_mfma_f32_16x16x32_bf16 v[116:119], v[48:51], v[228:231], v[116:119]
s_waitcnt lgkmcnt(10)
v_mfma_f32_16x16x32_bf16 v[120:123], v[52:55], v[224:227], v[120:123]
v_mfma_f32_16x16x32_bf16 v[124:127], v[52:55], v[228:231], v[124:127]
s_waitcnt vmcnt(11) lgkmcnt(0)
s_barrier
v_mfma_f32_16x16x32_bf16 v[96:99], v[56:59], v[232:235], v[96:99]
ds_read_b128 v[240:243], v7 offset:32768
ds_read_b64_tr_b16 v[40:41], v9 offset:34816
s_add_u32 m0, s48, 65536
s_bfe_u32 s52, s47, 262144
s_add_u32 s52, s52, s89
s_and_b32 s52, s52, 7
s_mul_i32 s94, s52, 229376
s_add_u32 s94, s94, s81
buffer_load_dwordx4 v5, s[8:11], s94 offen offset:0 lds
v_mfma_f32_16x16x32_bf16 v[100:103], v[56:59], v[236:239], v[100:103]
ds_read_b64_tr_b16 v[42:43], v9 offset:43008
ds_read_b128 v[244:247], v7 offset:36864
v_mfma_f32_16x16x32_bf16 v[104:107], v[60:63], v[232:235], v[104:107]
ds_read_b64_tr_b16 v[44:45], v10 offset:34816
ds_read_b64_tr_b16 v[46:47], v10 offset:43008
v_mfma_f32_16x16x32_bf16 v[108:111], v[60:63], v[236:239], v[108:111]
ds_read_b64_tr_b16 v[48:49], v9 offset:35840
ds_read_b64_tr_b16 v[50:51], v9 offset:44032
v_mfma_f32_16x16x32_bf16 v[112:115], v[64:67], v[232:235], v[112:115]
ds_read_b64_tr_b16 v[52:53], v10 offset:35840
ds_read_b64_tr_b16 v[54:55], v10 offset:44032
s_bfe_u32 s52, s47, 262148
s_add_u32 s52, s52, s89
s_and_b32 s52, s52, 7
s_mul_i32 s94, s52, 229376
s_add_u32 s94, s94, s81
s_sub_u32 s94, s94, 1024
buffer_load_dwordx4 v5, s[8:11], s94 offen offset:1024 lds
v_mfma_f32_16x16x32_bf16 v[116:119], v[64:67], v[236:239], v[116:119]
v_mfma_f32_16x16x32_bf16 v[120:123], v[68:71], v[232:235], v[120:123]
v_mfma_f32_16x16x32_bf16 v[124:127], v[68:71], v[236:239], v[124:127]
s_waitcnt lgkmcnt(7)
v_mfma_f32_16x16x32_bf16 v[96:99], v[40:43], v[240:243], v[96:99]
ds_read_b128 v[248:251], v8 offset:32768
ds_read_b64_tr_b16 v[56:57], v9 offset:51200
s_waitcnt vmcnt(11)
v_dot2_f32_bf16 v28, v88, v92, 0
v_dot2_f32_bf16 v28, v89, v93, v28
v_dot2_f32_bf16 v28, v90, v94, v28
v_dot2_f32_bf16 v28, v91, v95, v28
s_nop 2
v_add_f32_dpp v28, v28, v28 row_ror:1 row_mask:0xf bank_mask:0xf
s_waitcnt lgkmcnt(8)
v_mfma_f32_16x16x32_bf16 v[100:103], v[40:43], v[244:247], v[100:103]
ds_read_b64_tr_b16 v[58:59], v9 offset:59392
ds_read_b128 v[252:255], v8 offset:36864
v_add_f32_dpp v28, v28, v28 row_ror:2 row_mask:0xf bank_mask:0xf
s_nop 1
v_add_f32_dpp v28, v28, v28 row_ror:4 row_mask:0xf bank_mask:0xf
s_waitcnt lgkmcnt(8)
v_mfma_f32_16x16x32_bf16 v[104:107], v[44:47], v[240:243], v[104:107]
ds_read_b64_tr_b16 v[60:61], v10 offset:51200
ds_read_b64_tr_b16 v[62:63], v10 offset:59392
v_add_f32_dpp v28, v28, v28 row_ror:8 row_mask:0xf bank_mask:0xf
s_bfe_u32 s52, s47, 262152
s_add_u32 s52, s52, s89
s_and_b32 s52, s52, 7
s_mul_i32 s94, s52, 229376
s_add_u32 s94, s94, s81
s_sub_u32 s94, s94, 2048
buffer_load_dwordx4 v5, s[8:11], s94 offen offset:2048 lds
v_mfma_f32_16x16x32_bf16 v[108:111], v[44:47], v[244:247], v[108:111]
ds_read_b64_tr_b16 v[64:65], v9 offset:52224
ds_read_b64_tr_b16 v[66:67], v9 offset:60416
v_add_f32_dpp v28, v28, v28 row_bcast:15 row_mask:0xa bank_mask:0xf
s_nop 1
v_add_f32_dpp v28, v28, v28 row_bcast:31 row_mask:0xc bank_mask:0xf
s_waitcnt lgkmcnt(10)
v_mfma_f32_16x16x32_bf16 v[112:115], v[48:51], v[240:243], v[112:115]
ds_read_b64_tr_b16 v[68:69], v10 offset:52224
ds_read_b64_tr_b16 v[70:71], v10 offset:60416
v_mul_f32 v28, 0xbfb8aa3b, v28
v_exp_f32 v28, v28
s_nop 0
v_add_f32 v28, 1.0, v28
v_mfma_f32_16x16x32_bf16 v[116:119], v[48:51], v[244:247], v[116:119]
s_bfe_u32 s52, s47, 262156
s_add_u32 s52, s52, s89
s_and_b32 s52, s52, 7
s_mul_i32 s94, s52, 229376
s_add_u32 s94, s94, s81
s_sub_u32 s94, s94, 3072
buffer_load_dwordx4 v5, s[8:11], s94 offen offset:3072 lds
v_rcp_f32 v28, v28
s_waitcnt lgkmcnt(10)
v_mfma_f32_16x16x32_bf16 v[120:123], v[52:55], v[240:243], v[120:123]
v_mov_b32 v30, 2147483648
v_writelane_b32 v30, 0, 63
v_mfma_f32_16x16x32_bf16 v[124:127], v[52:55], v[244:247], v[124:127]
s_lshl2_add_u32 s55, s69, 65536
buffer_store_dword v28, v30, s[24:27], s55 offen offset:0 sc1
s_waitcnt vmcnt(10) lgkmcnt(0)
s_barrier
v_xor_b32 v9, 65536, v9
v_xor_b32 v10, 65536, v10
v_mfma_f32_16x16x32_bf16 v[96:99], v[56:59], v[248:251], v[96:99]
ds_read_b64_tr_b16 v[40:41], v9 offset:0
ds_read_b64_tr_b16 v[42:43], v9 offset:8192
v_mfma_f32_16x16x32_bf16 v[100:103], v[56:59], v[252:255], v[100:103]
ds_read_b64_tr_b16 v[44:45], v10 offset:0
ds_read_b64_tr_b16 v[46:47], v10 offset:8192
v_mfma_f32_16x16x32_bf16 v[104:107], v[60:63], v[248:251], v[104:107]
ds_read_b64_tr_b16 v[48:49], v9 offset:16384
ds_read_b64_tr_b16 v[50:51], v9 offset:24576
v_mfma_f32_16x16x32_bf16 v[108:111], v[60:63], v[252:255], v[108:111]
ds_read_b64_tr_b16 v[52:53], v10 offset:16384
ds_read_b64_tr_b16 v[54:55], v10 offset:24576
v_mfma_f32_16x16x32_bf16 v[112:115], v[64:67], v[248:251], v[112:115]
v_mfma_f32_16x16x32_bf16 v[116:119], v[64:67], v[252:255], v[116:119]
v_mfma_f32_16x16x32_bf16 v[120:123], v[68:71], v[248:251], v[120:123]
v_mfma_f32_16x16x32_bf16 v[124:127], v[68:71], v[252:255], v[124:127]
s_waitcnt vmcnt(7)
v_readfirstlane_b32 s58, v34
s_nop 0
s_cmp_lg_u32 s58, 0
s_cbranch_scc1 Lnk32
s_mov_b32 s69, 0
Lns33:
buffer_load_dword v34, v35, s[32:35], 0 offen sc1
s_add_u32 s69, s69, 1
s_waitcnt vmcnt(0)
v_readfirstlane_b32 s58, v34
s_cmp_ge_u32 s69, 0x100000
s_cbranch_scc1 Lnk32
s_cmp_eq_u32 s58, 0
s_cbranch_scc1 Lns33
Lnk32:
s_waitcnt lgkmcnt(6)
v_mfma_f32_16x16x32_bf16 v[72:75], v[40:43], v[128:131], v[36:39]
ds_read_b64_tr_b16 v[56:57], v9 offset:1024
ds_read_b64_tr_b16 v[58:59], v9 offset:9216
v_cvt_pk_bf16_f32 v96, v96, v97
v_cvt_pk_bf16_f32 v97, v98, v99
v_cvt_pk_bf16_f32 v98, v100, v101
v_mfma_f32_16x16x32_bf16 v[76:79], v[40:43], v[132:135], v[36:39]
ds_read_b64_tr_b16 v[60:61], v10 offset:1024
ds_read_b64_tr_b16 v[62:63], v10 offset:9216
v_cvt_pk_bf16_f32 v99, v102, v103
v_pk_max_i16 v96, v96, 0
v_pk_max_i16 v97, v97, 0
s_waitcnt lgkmcnt(8)
v_mfma_f32_16x16x32_bf16 v[80:83], v[44:47], v[128:131], v[36:39]
ds_read_b64_tr_b16 v[64:65], v9 offset:17408
ds_read_b64_tr_b16 v[66:67], v9 offset:25600
v_pk_max_i16 v98, v98, 0
v_pk_max_i16 v99, v99, 0
s_nop 0
v_permlane32_swap_b32 v96, v98
v_mfma_f32_16x16x32_bf16 v[84:87], v[44:47], v[132:135], v[36:39]
ds_read_b64_tr_b16 v[68:69], v10 offset:17408
ds_read_b64_tr_b16 v[70:71], v10 offset:25600
v_permlane32_swap_b32 v97, v99
buffer_store_dwordx4 v[96:99], v14, s[24:27], s83 offen offset:0 sc1
s_waitcnt lgkmcnt(10)
v_mfma_f32_16x16x32_bf16 v[72:75], v[48:51], v[136:139], v[72:75]
v_cvt_pk_bf16_f32 v104, v104, v105
v_cvt_pk_bf16_f32 v105, v106, v107
v_cvt_pk_bf16_f32 v106, v108, v109
v_mfma_f32_16x16x32_bf16 v[76:79], v[48:51], v[140:143], v[76:79]
v_cvt_pk_bf16_f32 v107, v110, v111
v_pk_max_i16 v104, v104, 0
v_pk_max_i16 v105, v105, 0
s_waitcnt lgkmcnt(8)
v_mfma_f32_16x16x32_bf16 v[80:83], v[52:55], v[136:139], v[80:83]
v_pk_max_i16 v106, v106, 0
v_pk_max_i16 v107, v107, 0
s_nop 0
v_permlane32_swap_b32 v104, v106
v_mfma_f32_16x16x32_bf16 v[84:87], v[52:55], v[140:143], v[84:87]
v_permlane32_swap_b32 v105, v107
buffer_store_dwordx4 v[104:107], v14, s[24:27], s83 offen offset:512 sc1
s_waitcnt lgkmcnt(6)
v_mfma_f32_16x16x32_bf16 v[72:75], v[56:59], v[144:147], v[72:75]
ds_read_b64_tr_b16 v[40:41], v9 offset:2048
ds_read_b64_tr_b16 v[42:43], v9 offset:10240
v_cvt_pk_bf16_f32 v112, v112, v113
v_cvt_pk_bf16_f32 v113, v114, v115
v_cvt_pk_bf16_f32 v114, v116, v117
v_mfma_f32_16x16x32_bf16 v[76:79], v[56:59], v[148:151], v[76:79]
ds_read_b64_tr_b16 v[44:45], v10 offset:2048
ds_read_b64_tr_b16 v[46:47], v10 offset:10240
v_cvt_pk_bf16_f32 v115, v118, v119
v_pk_max_i16 v112, v112, 0
v_pk_max_i16 v113, v113, 0
s_waitcnt lgkmcnt(8)
v_mfma_f32_16x16x32_bf16 v[80:83], v[60:63], v[144:147], v[80:83]
ds_read_b64_tr_b16 v[48:49], v9 offset:18432
ds_read_b64_tr_b16 v[50:51], v9 offset:26624
v_pk_max_i16 v114, v114, 0
v_pk_max_i16 v115, v115, 0
s_nop 0
v_permlane32_swap_b32 v112, v114
v_mfma_f32_16x16x32_bf16 v[84:87], v[60:63], v[148:151], v[84:87]
ds_read_b64_tr_b16 v[52:53], v10 offset:18432
ds_read_b64_tr_b16 v[54:55], v10 offset:26624
v_permlane32_swap_b32 v113, v115
buffer_store_dwordx4 v[112:115], v14, s[24:27], s83 offen offset:2048 sc1
v_cvt_pk_bf16_f32 v120, v120, v121
s_waitcnt lgkmcnt(10)
v_mfma_f32_16x16x32_bf16 v[72:75], v[64:67], v[152:155], v[72:75]
v_cvt_pk_bf16_f32 v121, v122, v123
v_cvt_pk_bf16_f32 v122, v124, v125
v_cvt_pk_bf16_f32 v123, v126, v127
v_mfma_f32_16x16x32_bf16 v[76:79], v[64:67], v[156:159], v[76:79]
v_pk_max_i16 v120, v120, 0
v_pk_max_i16 v121, v121, 0
v_pk_max_i16 v122, v122, 0
s_waitcnt lgkmcnt(8)
v_mfma_f32_16x16x32_bf16 v[80:83], v[68:71], v[152:155], v[80:83]
v_pk_max_i16 v123, v123, 0
v_permlane32_swap_b32 v120, v122
s_nop 0
v_permlane32_swap_b32 v121, v123
v_mfma_f32_16x16x32_bf16 v[84:87], v[68:71], v[156:159], v[84:87]
buffer_store_dwordx4 v[120:123], v14, s[24:27], s83 offen offset:2560 sc1
s_waitcnt lgkmcnt(6)
v_mfma_f32_16x16x32_bf16 v[72:75], v[40:43], v[160:163], v[72:75]
ds_read_b64_tr_b16 v[56:57], v9 offset:3072
ds_read_b64_tr_b16 v[58:59], v9 offset:11264
s_add_u32 m0, s48, 98304
s_bfe_u32 s52, s47, 262160
s_add_u32 s52, s52, s89
s_and_b32 s52, s52, 7
s_mul_i32 s94, s52, 229376
s_add_u32 s94, s94, s81
buffer_load_dwordx4 v5, s[8:11], s94 offen offset:0 lds
v_mfma_f32_16x16x32_bf16 v[76:79], v[40:43], v[164:167], v[76:79]
ds_read_b64_tr_b16 v[60:61], v10 offset:3072
ds_read_b64_tr_b16 v[62:63], v10 offset:11264
s_waitcnt lgkmcnt(8)
v_mfma_f32_16x16x32_bf16 v[80:83], v[44:47], v[160:163], v[80:83]
ds_read_b64_tr_b16 v[64:65], v9 offset:19456
ds_read_b64_tr_b16 v[66:67], v9 offset:27648
v_mfma_f32_16x16x32_bf16 v[84:87], v[44:47], v[164:167], v[84:87]
ds_read_b64_tr_b16 v[68:69], v10 offset:19456
ds_read_b64_tr_b16 v[70:71], v10 offset:27648
s_waitcnt lgkmcnt(10)
v_mfma_f32_16x16x32_bf16 v[72:75], v[48:51], v[168:171], v[72:75]
s_bfe_u32 s52, s47, 262164
s_add_u32 s52, s52, s89
s_and_b32 s52, s52, 7
s_mul_i32 s94, s52, 229376
s_add_u32 s94, s94, s81
s_sub_u32 s94, s94, 1024
buffer_load_dwordx4 v5, s[8:11], s94 offen offset:1024 lds
v_mfma_f32_16x16x32_bf16 v[76:79], v[48:51], v[172:175], v[76:79]
s_waitcnt lgkmcnt(8)
v_mfma_f32_16x16x32_bf16 v[80:83], v[52:55], v[168:171], v[80:83]
v_mfma_f32_16x16x32_bf16 v[84:87], v[52:55], v[172:175], v[84:87]
s_waitcnt vmcnt(11) lgkmcnt(0)
s_barrier
v_mfma_f32_16x16x32_bf16 v[72:75], v[56:59], v[176:179], v[72:75]
ds_read_b64_tr_b16 v[40:41], v9 offset:32768
ds_read_b64_tr_b16 v[42:43], v9 offset:40960
s_bfe_u32 s52, s47, 262168
s_add_u32 s52, s52, s89
s_and_b32 s52, s52, 7
s_mul_i32 s94, s52, 229376
s_add_u32 s94, s94, s81
s_sub_u32 s94, s94, 2048
buffer_load_dwordx4 v5, s[8:11], s94 offen offset:2048 lds
v_mfma_f32_16x16x32_bf16 v[76:79], v[56:59], v[180:183], v[76:79]
ds_read_b64_tr_b16 v[44:45], v10 offset:32768
ds_read_b64_tr_b16 v[46:47], v10 offset:40960
v_mfma_f32_16x16x32_bf16 v[80:83], v[60:63], v[176:179], v[80:83]
ds_read_b64_tr_b16 v[48:49], v9 offset:49152
ds_read_b64_tr_b16 v[50:51], v9 offset:57344
v_mfma_f32_16x16x32_bf16 v[84:87], v[60:63], v[180:183], v[84:87]
ds_read_b64_tr_b16 v[52:53], v10 offset:49152
ds_read_b64_tr_b16 v[54:55], v10 offset:57344
v_mfma_f32_16x16x32_bf16 v[72:75], v[64:67], v[184:187], v[72:75]
s_bfe_u32 s52, s47, 262172
s_add_u32 s52, s52, s89
s_and_b32 s52, s52, 7
s_mul_i32 s94, s52, 229376
s_add_u32 s94, s94, s81
s_sub_u32 s94, s94, 3072
buffer_load_dwordx4 v5, s[8:11], s94 offen offset:3072 lds
v_mfma_f32_16x16x32_bf16 v[76:79], v[64:67], v[188:191], v[76:79]
v_mfma_f32_16x16x32_bf16 v[80:83], v[68:71], v[184:187], v[80:83]
v_mfma_f32_16x16x32_bf16 v[84:87], v[68:71], v[188:191], v[84:87]
s_waitcnt lgkmcnt(6)
v_mfma_f32_16x16x32_bf16 v[72:75], v[40:43], v[192:195], v[72:75]
ds_read_b64_tr_b16 v[56:57], v9 offset:33792
ds_read_b64_tr_b16 v[58:59], v9 offset:41984
s_add_u32 m0, s48, 0
s_bfe_u32 s94, s70, 262144
s_lshl_b32 s94, s94, 15
s_add_u32 s94, s94, s76
buffer_load_dwordx4 v16, s[20:23], s94 offen offset:0 lds
v_mfma_f32_16x16x32_bf16 v[76:79], v[40:43], v[196:199], v[76:79]
ds_read_b64_tr_b16 v[60:61], v10 offset:33792
ds_read_b64_tr_b16 v[62:63], v10 offset:41984
s_waitcnt lgkmcnt(8)
v_mfma_f32_16x16x32_bf16 v[80:83], v[44:47], v[192:195], v[80:83]
ds_read_b64_tr_b16 v[64:65], v9 offset:50176
ds_read_b64_tr_b16 v[66:67], v9 offset:58368
v_mfma_f32_16x16x32_bf16 v[84:87], v[44:47], v[196:199], v[84:87]
ds_read_b64_tr_b16 v[68:69], v10 offset:50176
ds_read_b64_tr_b16 v[70:71], v10 offset:58368
s_waitcnt lgkmcnt(10)
v_mfma_f32_16x16x32_bf16 v[72:75], v[48:51], v[200:203], v[72:75]
buffer_load_dwordx4 v17, s[20:23], s94 offen offset:1024 lds
v_mfma_f32_16x16x32_bf16 v[76:79], v[48:51], v[204:207], v[76:79]
s_waitcnt lgkmcnt(8)
v_mfma_f32_16x16x32_bf16 v[80:83], v[52:55], v[200:203], v[80:83]
v_mfma_f32_16x16x32_bf16 v[84:87], v[52:55], v[204:207], v[84:87]
s_waitcnt vmcnt(6) lgkmcnt(0)
s_barrier
s_cmp_lg_u32 s40, 7
s_cbranch_scc1 Lfs34
s_lshl_b32 s56, s43, 8
s_add_u32 s56, s56, 2048
s_add_u32 s56, s56, s64
v_mov_b32 v32, s58
v_mov_b32 v33, 2147483648
v_writelane_b32 v33, 0, 0
buffer_store_dword v32, v33, s[24:27], s56 offen sc1
Lfs34:
v_mfma_f32_16x16x32_bf16 v[72:75], v[56:59], v[208:211], v[72:75]
ds_read_b64_tr_b16 v[40:41], v9 offset:34816
ds_read_b64_tr_b16 v[42:43], v9 offset:43008
s_bfe_u32 s94, s70, 262148
s_lshl_b32 s94, s94, 15
s_add_u32 s94, s94, s76
s_sub_u32 s94, s94, 2048
buffer_load_dwordx4 v16, s[20:23], s94 offen offset:2048 lds
v_mfma_f32_16x16x32_bf16 v[76:79], v[56:59], v[212:215], v[76:79]
ds_read_b64_tr_b16 v[44:45], v10 offset:34816
ds_read_b64_tr_b16 v[46:47], v10 offset:43008
v_mfma_f32_16x16x32_bf16 v[80:83], v[60:63], v[208:211], v[80:83]
ds_read_b64_tr_b16 v[48:49], v9 offset:51200
ds_read_b64_tr_b16 v[50:51], v9 offset:59392
v_mfma_f32_16x16x32_bf16 v[84:87], v[60:63], v[212:215], v[84:87]
ds_read_b64_tr_b16 v[52:53], v10 offset:51200
ds_read_b64_tr_b16 v[54:55], v10 offset:59392
v_mfma_f32_16x16x32_bf16 v[72:75], v[64:67], v[216:219], v[72:75]
buffer_load_dwordx4 v17, s[20:23], s94 offen offset:3072 lds
v_mfma_f32_16x16x32_bf16 v[76:79], v[64:67], v[220:223], v[76:79]
v_mfma_f32_16x16x32_bf16 v[80:83], v[68:71], v[216:219], v[80:83]
v_mfma_f32_16x16x32_bf16 v[84:87], v[68:71], v[220:223], v[84:87]
s_waitcnt lgkmcnt(6)
v_mfma_f32_16x16x32_bf16 v[72:75], v[40:43], v[224:227], v[72:75]
ds_read_b64_tr_b16 v[56:57], v9 offset:35840
ds_read_b64_tr_b16 v[58:59], v9 offset:44032
v_mfma_f32_16x16x32_bf16 v[76:79], v[40:43], v[228:231], v[76:79]
ds_read_b64_tr_b16 v[60:61], v10 offset:35840
ds_read_b64_tr_b16 v[62:63], v10 offset:44032
s_waitcnt lgkmcnt(8)
v_mfma_f32_16x16x32_bf16 v[80:83], v[44:47], v[224:227], v[80:83]
ds_read_b64_tr_b16 v[64:65], v9 offset:52224
ds_read_b64_tr_b16 v[66:67], v9 offset:60416
v_mfma_f32_16x16x32_bf16 v[84:87], v[44:47], v[228:231], v[84:87]
ds_read_b64_tr_b16 v[68:69], v10 offset:52224
ds_read_b64_tr_b16 v[70:71], v10 offset:60416
s_waitcnt lgkmcnt(10)
v_mfma_f32_16x16x32_bf16 v[72:75], v[48:51], v[232:235], v[72:75]
v_mfma_f32_16x16x32_bf16 v[76:79], v[48:51], v[236:239], v[76:79]
s_waitcnt lgkmcnt(8)
v_mfma_f32_16x16x32_bf16 v[80:83], v[52:55], v[232:235], v[80:83]
v_mfma_f32_16x16x32_bf16 v[84:87], v[52:55], v[236:239], v[84:87]
s_waitcnt lgkmcnt(0)
s_barrier
v_xor_b32 v11, 65536, v11
v_mfma_f32_16x16x32_bf16 v[72:75], v[56:59], v[240:243], v[72:75]
ds_read_b64_tr_b16 v[40:41], v11 offset:0
ds_read_b64_tr_b16 v[42:43], v11 offset:8192
s_add_u32 m0, s48, 32768
s_bfe_u32 s94, s70, 262152
s_lshl_b32 s94, s94, 15
s_add_u32 s94, s94, s76
buffer_load_dwordx4 v16, s[20:23], s94 offen offset:0 lds
v_mfma_f32_16x16x32_bf16 v[76:79], v[56:59], v[244:247], v[76:79]
ds_read_b64_tr_b16 v[44:45], v11 offset:16384
ds_read_b64_tr_b16 v[46:47], v11 offset:24576
v_mfma_f32_16x16x32_bf16 v[80:83], v[60:63], v[240:243], v[80:83]
ds_read_b64_tr_b16 v[48:49], v11 offset:1024
ds_read_b64_tr_b16 v[50:51], v11 offset:9216
v_mfma_f32_16x16x32_bf16 v[84:87], v[60:63], v[244:247], v[84:87]
ds_read_b64_tr_b16 v[52:53], v11 offset:17408
ds_read_b64_tr_b16 v[54:55], v11 offset:25600
v_mfma_f32_16x16x32_bf16 v[72:75], v[64:67], v[248:251], v[72:75]
buffer_load_dwordx4 v17, s[20:23], s94 offen offset:1024 lds
v_mfma_f32_16x16x32_bf16 v[76:79], v[64:67], v[252:255], v[76:79]
v_mfma_f32_16x16x32_bf16 v[80:83], v[68:71], v[248:251], v[80:83]
v_mfma_f32_16x16x32_bf16 v[84:87], v[68:71], v[252:255], v[84:87]
s_add_u32 s56, s65, 2048
buffer_load_dword v2, v22, s[24:27], s56 offen sc1
s_waitcnt lgkmcnt(6)
v_mfma_f32_16x16x32_bf16 v[88:91], v[40:43], v[128:131], 0
ds_read_b64_tr_b16 v[56:57], v11 offset:2048
ds_read_b64_tr_b16 v[58:59], v11 offset:10240
v_mov_b32 v31, s68
v_fma_f32 v23, v72, s66, v31
v_fma_f32 v24, v73, s66, v31
v_fma_f32 v25, v74, s66, v31
v_mfma_f32_16x16x32_bf16 v[92:95], v[40:43], v[132:135], 0
ds_read_b64_tr_b16 v[60:61], v11 offset:18432
ds_read_b64_tr_b16 v[62:63], v11 offset:26624
v_fma_f32 v26, v75, s66, v31
v_exp_f32_e64 v23, v23 clamp
v_exp_f32_e64 v24, v24 clamp
s_waitcnt lgkmcnt(8)
v_mfma_f32_16x16x32_bf16 v[88:91], v[44:47], v[136:139], v[88:91]
ds_read_b64_tr_b16 v[64:65], v11 offset:3072
ds_read_b64_tr_b16 v[66:67], v11 offset:11264
v_exp_f32_e64 v25, v25 clamp
s_bfe_u32 s94, s70, 262156
s_lshl_b32 s94, s94, 15
s_add_u32 s94, s94, s76
s_sub_u32 s94, s94, 2048
buffer_load_dwordx4 v16, s[20:23], s94 offen offset:2048 lds
v_exp_f32_e64 v26, v26 clamp
v_mfma_f32_16x16x32_bf16 v[92:95], v[44:47], v[140:143], v[92:95]
ds_read_b64_tr_b16 v[68:69], v11 offset:19456
ds_read_b64_tr_b16 v[70:71], v11 offset:27648
v_max_f32 v72, s67, v72
v_max_f32 v73, s67, v73
v_max_f32 v74, s67, v74
s_waitcnt lgkmcnt(10)
v_mfma_f32_16x16x32_bf16 v[88:91], v[48:51], v[144:147], v[88:91]
v_max_f32 v75, s67, v75
v_add_f32 v72, v72, v23
v_add_f32 v73, v73, v24
v_add_f32 v74, v74, v25
v_mfma_f32_16x16x32_bf16 v[92:95], v[48:51], v[148:151], v[92:95]
buffer_load_dwordx4 v17, s[20:23], s94 offen offset:3072 lds
v_add_f32 v75, v75, v26
v_fma_f32 v27, v76, s66, v31
s_waitcnt lgkmcnt(8)
v_mfma_f32_16x16x32_bf16 v[88:91], v[52:55], v[152:155], v[88:91]
v_fma_f32 v28, v77, s66, v31
v_fma_f32 v29, v78, s66, v31
v_fma_f32 v30, v79, s66, v31
v_mfma_f32_16x16x32_bf16 v[92:95], v[52:55], v[156:159], v[92:95]
v_exp_f32_e64 v27, v27 clamp
v_exp_f32_e64 v28, v28 clamp
v_exp_f32_e64 v29, v29 clamp
s_waitcnt vmcnt(9) lgkmcnt(0)
s_barrier
v_mfma_f32_16x16x32_bf16 v[88:91], v[56:59], v[160:163], v[88:91]
ds_read_b64_tr_b16 v[40:41], v11 offset:32768
ds_read_b64_tr_b16 v[42:43], v11 offset:40960
v_exp_f32_e64 v30, v30 clamp
v_max_f32 v76, s67, v76
v_max_f32 v77, s67, v77
v_max_f32 v78, s67, v78
v_mfma_f32_16x16x32_bf16 v[92:95], v[56:59], v[164:167], v[92:95]
ds_read_b64_tr_b16 v[44:45], v11 offset:49152
ds_read_b64_tr_b16 v[46:47], v11 offset:57344
v_max_f32 v79, s67, v79
s_add_u32 m0, s48, 65536
s_bfe_u32 s94, s70, 262160
s_lshl_b32 s94, s94, 15
s_add_u32 s94, s94, s76
buffer_load_dwordx4 v16, s[20:23], s94 offen offset:0 lds
v_add_f32 v76, v76, v27
v_mfma_f32_16x16x32_bf16 v[88:91], v[60:63], v[168:171], v[88:91]
ds_read_b64_tr_b16 v[48:49], v11 offset:33792
ds_read_b64_tr_b16 v[50:51], v11 offset:41984
v_add_f32 v77, v77, v28
v_add_f32 v78, v78, v29
v_add_f32 v79, v79, v30
v_fma_f32 v23, v80, s66, v31
v_mfma_f32_16x16x32_bf16 v[92:95], v[60:63], v[172:175], v[92:95]
ds_read_b64_tr_b16 v[52:53], v11 offset:50176
ds_read_b64_tr_b16 v[54:55], v11 offset:58368
buffer_load_dwordx4 v17, s[20:23], s94 offen offset:1024 lds
v_fma_f32 v24, v81, s66, v31
v_fma_f32 v25, v82, s66, v31
v_mfma_f32_16x16x32_bf16 v[88:91], v[64:67], v[176:179], v[88:91]
v_fma_f32 v26, v83, s66, v31
v_exp_f32_e64 v23, v23 clamp
v_exp_f32_e64 v24, v24 clamp
s_bfe_u32 s94, s70, 262164
s_lshl_b32 s94, s94, 15
s_add_u32 s94, s94, s76
s_sub_u32 s94, s94, 2048
buffer_load_dwordx4 v16, s[20:23], s94 offen offset:2048 lds
v_mfma_f32_16x16x32_bf16 v[92:95], v[64:67], v[180:183], v[92:95]
v_exp_f32_e64 v25, v25 clamp
v_exp_f32_e64 v26, v26 clamp
v_max_f32 v80, s67, v80
v_mfma_f32_16x16x32_bf16 v[88:91], v[68:71], v[184:187], v[88:91]
v_max_f32 v81, s67, v81
v_max_f32 v82, s67, v82
buffer_load_dwordx4 v17, s[20:23], s94 offen offset:3072 lds
v_max_f32 v83, s67, v83
v_mfma_f32_16x16x32_bf16 v[92:95], v[68:71], v[188:191], v[92:95]
v_add_f32 v80, v80, v23
v_add_f32 v81, v81, v24
v_add_f32 v82, v82, v25
s_waitcnt vmcnt(6)
v_cmp_ne_u32 vcc, s58, v2
s_nop 0
s_cbranch_vccz Lok35
s_add_u32 s56, s65, 2048
s_mov_b32 s69, 0
Lsp36:
buffer_load_dword v2, v22, s[24:27], s56 offen sc1
s_add_u32 s69, s69, 1
s_waitcnt vmcnt(0)
v_cmp_ne_u32 vcc, s58, v2
s_cmp_ge_u32 s69, 0x100000
s_cbranch_scc1 Lok35
s_cbranch_vccnz Lsp36
Lok35:
s_waitcnt lgkmcnt(6)
v_mfma_f32_16x16x32_bf16 v[88:91], v[40:43], v[192:195], v[88:91]
ds_read_b64_tr_b16 v[56:57], v11 offset:34816
ds_read_b64_tr_b16 v[58:59], v11 offset:43008
v_add_f32 v83, v83, v26
v_fma_f32 v27, v84, s66, v31
v_fma_f32 v28, v85, s66, v31
v_fma_f32 v29, v86, s66, v31
v_mfma_f32_16x16x32_bf16 v[92:95], v[40:43], v[196:199], v[92:95]
ds_read_b64_tr_b16 v[60:61], v11 offset:51200
ds_read_b64_tr_b16 v[62:63], v11 offset:59392
s_bfe_u32 s93, s70, 262144
s_lshl_b32 s93, s93, 10
s_add_u32 s93, s93, s74
buffer_load_dwordx4 v[96:99], v15, s[24:27], s93 offen sc1
v_fma_f32 v30, v87, s66, v31
v_exp_f32_e64 v27, v27 clamp
v_exp_f32_e64 v28, v28 clamp
s_waitcnt lgkmcnt(8)
v_mfma_f32_16x16x32_bf16 v[88:91], v[44:47], v[200:203], v[88:91]
ds_read_b64_tr_b16 v[64:65], v11 offset:35840
ds_read_b64_tr_b16 v[66:67], v11 offset:44032
v_exp_f32_e64 v29, v29 clamp
s_add_u32 s93, s93, 73728
buffer_load_dwordx4 v[100:103], v15, s[24:27], s93 offen sc1
v_exp_f32_e64 v30, v30 clamp
v_max_f32 v84, s67, v84
v_mfma_f32_16x16x32_bf16 v[92:95], v[44:47], v[204:207], v[92:95]
ds_read_b64_tr_b16 v[68:69], v11 offset:52224
ds_read_b64_tr_b16 v[70:71], v11 offset:60416
v_max_f32 v85, s67, v85
s_bfe_u32 s93, s70, 262148
s_lshl_b32 s93, s93, 10
s_add_u32 s93, s93, s74
buffer_load_dwordx4 v[104:107], v15, s[24:27], s93 offen sc1
v_max_f32 v86, s67, v86
v_max_f32 v87, s67, v87
s_waitcnt lgkmcnt(10)
v_mfma_f32_16x16x32_bf16 v[88:91], v[48:51], v[208:211], v[88:91]
v_add_f32 v84, v84, v27
v_add_f32 v85, v85, v28
s_add_u32 s93, s93, 73728
buffer_load_dwordx4 v[108:111], v15, s[24:27], s93 offen sc1
v_add_f32 v86, v86, v29
v_mfma_f32_16x16x32_bf16 v[92:95], v[48:51], v[212:215], v[92:95]
v_add_f32 v87, v87, v30
v_cvt_pk_bf16_f32 v72, v72, v73
s_bfe_u32 s93, s70, 262152
s_lshl_b32 s93, s93, 10
s_add_u32 s93, s93, s74
buffer_load_dwordx4 v[112:115], v15, s[24:27], s93 offen sc1
v_cvt_pk_bf16_f32 v73, v74, v75
s_waitcnt lgkmcnt(8)
v_mfma_f32_16x16x32_bf16 v[88:91], v[52:55], v[216:219], v[88:91]
v_cvt_pk_bf16_f32 v74, v80, v81
v_cvt_pk_bf16_f32 v75, v82, v83
v_cvt_pk_bf16_f32 v76, v76, v77
s_add_u32 s93, s93, 73728
buffer_load_dwordx4 v[116:119], v15, s[24:27], s93 offen sc1
v_mfma_f32_16x16x32_bf16 v[92:95], v[52:55], v[220:223], v[92:95]
v_cvt_pk_bf16_f32 v77, v78, v79
v_cvt_pk_bf16_f32 v78, v84, v85
v_cvt_pk_bf16_f32 v79, v86, v87
s_waitcnt lgkmcnt(6)
v_mfma_f32_16x16x32_bf16 v[88:91], v[56:59], v[224:227], v[88:91]
v_mfma_f32_16x16x32_bf16 v[92:95], v[56:59], v[228:231], v[92:95]
s_waitcnt lgkmcnt(4)
v_mfma_f32_16x16x32_bf16 v[88:91], v[60:63], v[232:235], v[88:91]
v_mfma_f32_16x16x32_bf16 v[92:95], v[60:63], v[236:239], v[92:95]
s_waitcnt lgkmcnt(2)
v_mfma_f32_16x16x32_bf16 v[88:91], v[64:67], v[240:243], v[88:91]
v_mfma_f32_16x16x32_bf16 v[92:95], v[64:67], v[244:247], v[92:95]
s_waitcnt lgkmcnt(0)
v_mfma_f32_16x16x32_bf16 v[88:91], v[68:71], v[248:251], v[88:91]
v_mfma_f32_16x16x32_bf16 v[92:95], v[68:71], v[252:255], v[92:95]
s_nop 6
v_cvt_pk_bf16_f32 v88, v88, v89
v_cvt_pk_bf16_f32 v89, v90, v91
v_cvt_pk_bf16_f32 v90, v92, v93
v_cvt_pk_bf16_f32 v91, v94, v95
v_pk_max_i16 v88, v88, 0
v_pk_max_i16 v89, v89, 0
v_pk_max_i16 v90, v90, 0
v_pk_max_i16 v91, v91, 0
s_nop 0
v_permlane32_swap_b32 v88, v90
v_permlane32_swap_b32 v89, v91
buffer_store_dwordx4 v[88:91], v14, s[24:27], s87 offen offset:0 sc1
s_barrier
ds_read_b64_tr_b16 v[40:41], v18 offset:0
ds_read_b64_tr_b16 v[42:43], v18 offset:16384
ds_read_b64_tr_b16 v[44:45], v19 offset:0
ds_read_b64_tr_b16 v[46:47], v19 offset:16384
ds_read_b64_tr_b16 v[48:49], v20 offset:0
ds_read_b64_tr_b16 v[50:51], v20 offset:16384
ds_read_b64_tr_b16 v[52:53], v21 offset:0
ds_read_b64_tr_b16 v[54:55], v21 offset:16384
s_add_u32 m0, s48, 98304
s_bfe_u32 s94, s70, 262168
s_lshl_b32 s94, s94, 15
s_add_u32 s94, s94, s76
buffer_load_dwordx4 v16, s[20:23], s94 offen offset:0 lds
buffer_load_dwordx4 v17, s[20:23], s94 offen offset:1024 lds
v_and_b32 v3, 15, v1
v_lshlrev_b32 v3, 2, v3
s_lshl_b32 s56, s46, 8
buffer_load_dword v35, v3, s[24:27], s56 offen sc1
s_waitcnt lgkmcnt(6)
s_waitcnt vmcnt(8)
v_mfma_f32_16x16x32_bf16 v[128:131], v[40:43], v[96:99], 0
ds_read_b64_tr_b16 v[56:57], v18 offset:2048
ds_read_b64_tr_b16 v[58:59], v18 offset:18432
s_bfe_u32 s93, s70, 262156
s_lshl_b32 s93, s93, 10
s_add_u32 s93, s93, s74
buffer_load_dwordx4 v[120:123], v15, s[24:27], s93 offen sc1
v_mov_b32 v191, 0x3f80
v_mfma_f32_16x16x32_bf16 v[144:147], v[40:43], v[100:103], 0
ds_read_b64_tr_b16 v[60:61], v19 offset:2048
ds_read_b64_tr_b16 v[62:63], v19 offset:18432
s_add_u32 s93, s93, 73728
buffer_load_dwordx4 v[124:127], v15, s[24:27], s93 offen sc1
v_bfe_u32 v188, v1, 2, 2
s_waitcnt lgkmcnt(8)
v_mfma_f32_16x16x32_bf16 v[132:135], v[44:47], v[96:99], 0
ds_read_b64_tr_b16 v[64:65], v20 offset:2048
ds_read_b64_tr_b16 v[66:67], v20 offset:18432
v_lshrrev_b32 v189, 4, v1
v_mfma_f32_16x16x32_bf16 v[148:151], v[44:47], v[100:103], 0
ds_read_b64_tr_b16 v[68:69], v21 offset:2048
ds_read_b64_tr_b16 v[70:71], v21 offset:18432
s_bfe_u32 s94, s70, 262172
s_lshl_b32 s94, s94, 15
s_add_u32 s94, s94, s76
s_sub_u32 s94, s94, 2048
buffer_load_dwordx4 v16, s[20:23], s94 offen offset:2048 lds
v_and_b32 v190, 1, v1
s_waitcnt lgkmcnt(10)
v_mfma_f32_16x16x32_bf16 v[136:139], v[48:51], v[96:99], 0
buffer_load_dwordx4 v17, s[20:23], s94 offen offset:3072 lds
v_lshlrev_b32 v190, 4, v190
v_mfma_f32_16x16x32_bf16 v[152:155], v[48:51], v[100:103], 0
v_cmp_eq_u32 vcc, v188, v189
v_lshlrev_b32 v190, v190, v191
s_nop 0
v_cndmask_b32 v176, 0, v190, vcc
s_waitcnt lgkmcnt(8)
v_mfma_f32_16x16x32_bf16 v[140:143], v[52:55], v[96:99], 0
v_mov_b32 v177, v176
v_mfma_f32_16x16x32_bf16 v[156:159], v[52:55], v[100:103], 0
s_waitcnt vmcnt(7) lgkmcnt(0)
s_barrier
s_cmp_lg_u32 s40, 7
s_cbranch_scc1 Lfs37
s_lshl_b32 s56, s43, 8
s_add_u32 s56, s56, 6144
s_add_u32 s56, s56, s82
v_mov_b32 v32, s58
v_mov_b32 v33, 2147483648
v_writelane_b32 v33, 0, 0
buffer_store_dword v32, v33, s[24:27], s56 offen sc1
Lfs37:
s_waitcnt vmcnt(4)
v_cmp_ne_u32 vcc, s58, v35
s_nop 0
s_cbranch_vccz Lok38
s_lshl_b32 s56, s46, 8
s_mov_b32 s69, 0
Lsp39:
buffer_load_dword v35, v3, s[24:27], s56 offen sc1
s_add_u32 s69, s69, 1
s_waitcnt vmcnt(0)
v_cmp_ne_u32 vcc, s58, v35
s_cmp_ge_u32 s69, 0x100000
s_cbranch_scc1 Lok38
s_cbranch_vccnz Lsp39
Lok38:
v_mfma_f32_16x16x32_bf16 v[128:131], v[56:59], v[104:107], v[128:131]
ds_read_b64_tr_b16 v[40:41], v18 offset:32768
ds_read_b64_tr_b16 v[42:43], v18 offset:49152
buffer_load_dwordx4 v[160:163], v15, s[24:27], s84 offen offset:0 sc1
buffer_load_dwordx4 v[164:167], v15, s[24:27], s84 offen offset:1024 sc1
v_mov_b32 v178, v176
v_mfma_f32_16x16x32_bf16 v[144:147], v[56:59], v[108:111], v[144:147]
ds_read_b64_tr_b16 v[44:45], v19 offset:32768
ds_read_b64_tr_b16 v[46:47], v19 offset:49152
buffer_load_dwordx4 v[168:171], v15, s[24:27], s84 offen offset:2048 sc1
buffer_load_dwordx4 v[172:175], v15, s[24:27], s84 offen offset:3072 sc1
v_mov_b32 v179, v176
v_mfma_f32_16x16x32_bf16 v[132:135], v[60:63], v[104:107], v[132:135]
ds_read_b64_tr_b16 v[48:49], v20 offset:32768
ds_read_b64_tr_b16 v[50:51], v20 offset:49152
buffer_load_dwordx4 v[224:227], v15, s[24:27], s85 offen offset:0 sc1
v_mov_b32 v180, 0x3f803f80
v_mfma_f32_16x16x32_bf16 v[148:151], v[60:63], v[108:111], v[148:151]
ds_read_b64_tr_b16 v[52:53], v21 offset:32768
ds_read_b64_tr_b16 v[54:55], v21 offset:49152
buffer_load_dwordx4 v[228:231], v15, s[24:27], s85 offen offset:1024 sc1
s_bfe_u32 s93, s70, 262160
s_lshl_b32 s93, s93, 10
s_add_u32 s93, s93, s74
buffer_load_dwordx4 v[192:195], v15, s[24:27], s93 offen sc1
v_mov_b32 v181, 0x3f803f80
v_mfma_f32_16x16x32_bf16 v[136:139], v[64:67], v[104:107], v[136:139]
s_add_u32 s93, s93, 73728
buffer_load_dwordx4 v[196:199], v15, s[24:27], s93 offen sc1
s_add_u32 m0, s48, 0
s_bfe_u32 s94, s72, 262144
s_lshl_b32 s94, s94, 15
s_add_u32 s94, s94, s76
buffer_load_dwordx4 v16, s[20:23], s94 offen offset:0 lds
v_mov_b32 v182, 0x3f803f80
v_mfma_f32_16x16x32_bf16 v[152:155], v[64:67], v[108:111], v[152:155]
buffer_load_dwordx4 v17, s[20:23], s94 offen offset:1024 lds
v_mov_b32 v183, 0x3f803f80
v_mfma_f32_16x16x32_bf16 v[140:143], v[68:71], v[104:107], v[140:143]
v_add_u32 v11, s79, v15
v_mfma_f32_16x16x32_bf16 v[156:159], v[68:71], v[108:111], v[156:159]
v_lshl_add_u32 v4, s41, 2, v11
s_waitcnt lgkmcnt(6)
v_mfma_f32_16x16x32_bf16 v[128:131], v[40:43], v[112:115], v[128:131]
ds_read_b64_tr_b16 v[56:57], v18 offset:34816
ds_read_b64_tr_b16 v[58:59], v18 offset:51200
s_bfe_u32 s93, s70, 262164
s_lshl_b32 s93, s93, 10
s_add_u32 s93, s93, s74
buffer_load_dwordx4 v[200:203], v15, s[24:27], s93 offen sc1
s_waitcnt vmcnt(5)
v_mfma_f32_16x16x32_bf16 v[184:187], v[176:179], v[160:163], 0
v_mfma_f32_16x16x32_bf16 v[144:147], v[40:43], v[116:119], v[144:147]
ds_read_b64_tr_b16 v[60:61], v19 offset:34816
ds_read_b64_tr_b16 v[62:63], v19 offset:51200
s_add_u32 s93, s93, 73728
buffer_load_dwordx4 v[204:207], v15, s[24:27], s93 offen sc1
v_mfma_f32_16x16x32_bf16 v[184:187], v[176:179], v[164:167], v[184:187]
v_mfma_f32_16x16x32_bf16 v[184:187], v[176:179], v[168:171], v[184:187]
s_waitcnt lgkmcnt(8)
v_mfma_f32_16x16x32_bf16 v[132:135], v[44:47], v[112:115], v[132:135]
ds_read_b64_tr_b16 v[64:65], v20 offset:34816
ds_read_b64_tr_b16 v[66:67], v20 offset:51200
v_mfma_f32_16x16x32_bf16 v[184:187], v[176:179], v[172:175], v[184:187]
v_mfma_f32_16x16x32_bf16 v[148:151], v[44:47], v[116:119], v[148:151]
ds_read_b64_tr_b16 v[68:69], v21 offset:34816
ds_read_b64_tr_b16 v[70:71], v21 offset:51200
s_bfe_u32 s94, s72, 262148
s_lshl_b32 s94, s94, 15
s_add_u32 s94, s94, s76
s_sub_u32 s94, s94, 2048
buffer_load_dwordx4 v16, s[20:23], s94 offen offset:2048 lds
v_mfma_f32_16x16x32_bf16 v[232:235], v[224:227], v[180:183], 0
v_mfma_f32_16x16x32_bf16 v[236:239], v[228:231], v[180:183], 0
s_waitcnt lgkmcnt(10)
v_mfma_f32_16x16x32_bf16 v[136:139], v[48:51], v[112:115], v[136:139]
buffer_load_dwordx4 v17, s[20:23], s94 offen offset:3072 lds
v_cvt_pk_bf16_f32 v184, v184, v185
ds_write_b32 v4, v184
v_mfma_f32_16x16x32_bf16 v[152:155], v[48:51], v[116:119], v[152:155]
s_nop 0
v_cvt_pk_bf16_f32 v166, v232, v233
s_waitcnt lgkmcnt(9)
v_mfma_f32_16x16x32_bf16 v[140:143], v[52:55], v[112:115], v[140:143]
v_cvt_pk_bf16_f32 v167, v234, v235
v_cvt_pk_bf16_f32 v170, v236, v237
v_mfma_f32_16x16x32_bf16 v[156:159], v[52:55], v[116:119], v[156:159]
v_cvt_pk_bf16_f32 v171, v238, v239
s_waitcnt lgkmcnt(0)
s_barrier
v_xor_b32 v18, 65536, v18
v_xor_b32 v19, 65536, v19
v_xor_b32 v20, 65536, v20
v_xor_b32 v21, 65536, v21
ds_read_b64 v[160:161], v11
ds_read_b64 v[164:165], v11 offset:8
v_mfma_f32_16x16x32_bf16 v[128:131], v[56:59], v[120:123], v[128:131]
ds_read_b64_tr_b16 v[40:41], v18 offset:0
ds_read_b64_tr_b16 v[42:43], v18 offset:16384
s_bfe_u32 s93, s70, 262168
s_lshl_b32 s93, s93, 10
s_add_u32 s93, s93, s74
buffer_load_dwordx4 v[208:211], v15, s[24:27], s93 offen sc1
v_mov_b32 v162, 0
v_mov_b32 v163, 0
v_mov_b32 v168, 0
v_mfma_f32_16x16x32_bf16 v[144:147], v[56:59], v[124:127], v[144:147]
ds_read_b64_tr_b16 v[44:45], v19 offset:0
ds_read_b64_tr_b16 v[46:47], v19 offset:16384
s_add_u32 s93, s93, 73728
buffer_load_dwordx4 v[212:215], v15, s[24:27], s93 offen sc1
v_mov_b32 v169, 0
s_waitcnt lgkmcnt(4)
s_nop 0
v_mfma_f32_16x16x32_bf16 v[224:227], v[166:169], v[72:75], v[36:39]
v_mfma_f32_16x16x32_bf16 v[132:135], v[60:63], v[120:123], v[132:135]
ds_read_b64_tr_b16 v[48:49], v20 offset:0
ds_read_b64_tr_b16 v[50:51], v20 offset:16384
v_mfma_f32_16x16x32_bf16 v[228:231], v[166:169], v[76:79], v[36:39]
v_mfma_f32_16x16x32_bf16 v[232:235], v[168:171], v[72:75], v[36:39]
v_mfma_f32_16x16x32_bf16 v[236:239], v[168:171], v[76:79], v[36:39]
v_mfma_f32_16x16x32_bf16 v[148:151], v[60:63], v[124:127], v[148:151]
ds_read_b64_tr_b16 v[52:53], v21 offset:0
ds_read_b64_tr_b16 v[54:55], v21 offset:16384
s_add_u32 m0, s48, 32768
s_bfe_u32 s94, s72, 262152
s_lshl_b32 s94, s94, 15
s_add_u32 s94, s94, s76
buffer_load_dwordx4 v16, s[20:23], s94 offen offset:0 lds
v_mfma_f32_16x16x32_bf16 v[80:83], v[160:163], v[72:75], 0
v_mfma_f32_16x16x32_bf16 v[84:87], v[160:163], v[76:79], 0
v_mfma_f32_16x16x32_bf16 v[88:91], v[162:165], v[72:75], 0
v_mfma_f32_16x16x32_bf16 v[136:139], v[64:67], v[120:123], v[136:139]
buffer_load_dwordx4 v17, s[20:23], s94 offen offset:1024 lds
v_mfma_f32_16x16x32_bf16 v[92:95], v[162:165], v[76:79], 0
v_rcp_f32 v224, v224
v_rcp_f32 v228, v228
v_mfma_f32_16x16x32_bf16 v[152:155], v[64:67], v[124:127], v[152:155]
v_rcp_f32 v232, v232
v_rcp_f32 v236, v236
v_mul_f32 v80, v80, v224
v_mfma_f32_16x16x32_bf16 v[140:143], v[68:71], v[120:123], v[140:143]
v_mul_f32 v81, v81, v224
v_mul_f32 v82, v82, v224
v_mul_f32 v83, v83, v224
v_mfma_f32_16x16x32_bf16 v[156:159], v[68:71], v[124:127], v[156:159]
v_mul_f32 v84, v84, v228
v_mul_f32 v85, v85, v228
v_mul_f32 v86, v86, v228
s_add_u32 s56, s65, 6144
buffer_load_dword v34, v12, s[24:27], s56 offen sc1
s_waitcnt lgkmcnt(6)
s_waitcnt vmcnt(11)
v_mfma_f32_16x16x32_bf16 v[128:131], v[40:43], v[192:195], v[128:131]
ds_read_b64_tr_b16 v[56:57], v18 offset:2048
ds_read_b64_tr_b16 v[58:59], v18 offset:18432
s_bfe_u32 s93, s70, 262172
s_lshl_b32 s93, s93, 10
s_add_u32 s93, s93, s74
buffer_load_dwordx4 v[216:219], v15, s[24:27], s93 offen sc1
v_mul_f32 v87, v87, v228
v_cvt_pk_bf16_f32 v80, v80, v81
v_cvt_pk_bf16_f32 v81, v82, v83
v_mfma_f32_16x16x32_bf16 v[144:147], v[40:43], v[196:199], v[144:147]
ds_read_b64_tr_b16 v[60:61], v19 offset:2048
ds_read_b64_tr_b16 v[62:63], v19 offset:18432
s_add_u32 s93, s93, 73728
buffer_load_dwordx4 v[220:223], v15, s[24:27], s93 offen sc1
v_cvt_pk_bf16_f32 v82, v84, v85
v_cvt_pk_bf16_f32 v83, v86, v87
s_nop 0
v_permlane32_swap_b32 v80, v82
s_waitcnt lgkmcnt(8)
v_mfma_f32_16x16x32_bf16 v[132:135], v[44:47], v[192:195], v[132:135]
ds_read_b64_tr_b16 v[64:65], v20 offset:2048
ds_read_b64_tr_b16 v[66:67], v20 offset:18432
v_permlane32_swap_b32 v81, v83
buffer_store_dwordx4 v[80:83], v14, s[24:27], s86 offen offset:0 sc1
v_mul_f32 v88, v88, v232
v_mfma_f32_16x16x32_bf16 v[148:151], v[44:47], v[196:199], v[148:151]
ds_read_b64_tr_b16 v[68:69], v21 offset:2048
ds_read_b64_tr_b16 v[70:71], v21 offset:18432
s_bfe_u32 s94, s72, 262156
s_lshl_b32 s94, s94, 15
s_add_u32 s94, s94, s76
s_sub_u32 s94, s94, 2048
buffer_load_dwordx4 v16, s[20:23], s94 offen offset:2048 lds
v_mul_f32 v89, v89, v232
v_mul_f32 v90, v90, v232
v_mul_f32 v91, v91, v232
s_waitcnt lgkmcnt(10)
v_mfma_f32_16x16x32_bf16 v[136:139], v[48:51], v[192:195], v[136:139]
buffer_load_dwordx4 v17, s[20:23], s94 offen offset:3072 lds
v_mul_f32 v92, v92, v236
v_mul_f32 v93, v93, v236
v_mul_f32 v94, v94, v236
v_mfma_f32_16x16x32_bf16 v[152:155], v[48:51], v[196:199], v[152:155]
v_mul_f32 v95, v95, v236
v_cvt_pk_bf16_f32 v88, v88, v89
v_cvt_pk_bf16_f32 v89, v90, v91
s_waitcnt lgkmcnt(8)
v_mfma_f32_16x16x32_bf16 v[140:143], v[52:55], v[192:195], v[140:143]
v_cvt_pk_bf16_f32 v90, v92, v93
v_cvt_pk_bf16_f32 v91, v94, v95
s_nop 0
v_permlane32_swap_b32 v88, v90
v_mfma_f32_16x16x32_bf16 v[156:159], v[52:55], v[196:199], v[156:159]
v_permlane32_swap_b32 v89, v91
buffer_store_dwordx4 v[88:91], v14, s[24:27], s86 offen offset:512 sc1
s_waitcnt lgkmcnt(0)
s_barrier
s_waitcnt vmcnt(6)
v_cmp_ne_u32 vcc, s58, v34
s_nop 0
s_cbranch_vccz Lok40
s_add_u32 s56, s65, 6144
s_mov_b32 s69, 0
Lsp41:
buffer_load_dword v34, v12, s[24:27], s56 offen sc1
s_add_u32 s69, s69, 1
s_waitcnt vmcnt(0)
v_cmp_ne_u32 vcc, s58, v34
s_cmp_ge_u32 s69, 0x100000
s_cbranch_scc1 Lok40
s_cbranch_vccnz Lsp41
Lok40:
v_mfma_f32_16x16x32_bf16 v[128:131], v[56:59], v[200:203], v[128:131]
ds_read_b64_tr_b16 v[40:41], v18 offset:32768
ds_read_b64_tr_b16 v[42:43], v18 offset:49152
s_bfe_u32 s93, s72, 262144
s_lshl_b32 s93, s93, 10
s_add_u32 s93, s93, s74
buffer_load_dwordx4 v[96:99], v15, s[24:27], s93 offen sc1
v_mfma_f32_16x16x32_bf16 v[144:147], v[56:59], v[204:207], v[144:147]
ds_read_b64_tr_b16 v[44:45], v19 offset:32768
ds_read_b64_tr_b16 v[46:47], v19 offset:49152
s_add_u32 s93, s93, 73728
buffer_load_dwordx4 v[100:103], v15, s[24:27], s93 offen sc1
v_mfma_f32_16x16x32_bf16 v[132:135], v[60:63], v[200:203], v[132:135]
ds_read_b64_tr_b16 v[48:49], v20 offset:32768
ds_read_b64_tr_b16 v[50:51], v20 offset:49152
v_mfma_f32_16x16x32_bf16 v[148:151], v[60:63], v[204:207], v[148:151]
ds_read_b64_tr_b16 v[52:53], v21 offset:32768
ds_read_b64_tr_b16 v[54:55], v21 offset:49152
s_add_u32 m0, s48, 65536
s_bfe_u32 s94, s72, 262160
s_lshl_b32 s94, s94, 15
s_add_u32 s94, s94, s76
buffer_load_dwordx4 v16, s[20:23], s94 offen offset:0 lds
v_mfma_f32_16x16x32_bf16 v[136:139], v[64:67], v[200:203], v[136:139]
buffer_load_dwordx4 v17, s[20:23], s94 offen offset:1024 lds
v_mfma_f32_16x16x32_bf16 v[152:155], v[64:67], v[204:207], v[152:155]
v_mfma_f32_16x16x32_bf16 v[140:143], v[68:71], v[200:203], v[140:143]
v_mfma_f32_16x16x32_bf16 v[156:159], v[68:71], v[204:207], v[156:159]
s_waitcnt vmcnt(4) lgkmcnt(0)
s_barrier
s_cmp_lg_u32 s40, 7
s_cbranch_scc1 Lfs42
s_lshl_b32 s56, s43, 8
s_add_u32 s56, s56, 10240
s_add_u32 s56, s56, s64
v_mov_b32 v32, s58
v_mov_b32 v33, 2147483648
v_writelane_b32 v33, 0, 0
buffer_store_dword v32, v33, s[24:27], s56 offen sc1
Lfs42:
v_mfma_f32_16x16x32_bf16 v[128:131], v[40:43], v[208:211], v[128:131]
ds_read_b64_tr_b16 v[56:57], v18 offset:34816
ds_read_b64_tr_b16 v[58:59], v18 offset:51200
s_bfe_u32 s93, s72, 262148
s_lshl_b32 s93, s93, 10
s_add_u32 s93, s93, s74
buffer_load_dwordx4 v[104:107], v15, s[24:27], s93 offen sc1
v_mfma_f32_16x16x32_bf16 v[144:147], v[40:43], v[212:215], v[144:147]
ds_read_b64_tr_b16 v[60:61], v19 offset:34816
ds_read_b64_tr_b16 v[62:63], v19 offset:51200
s_add_u32 s93, s93, 73728
buffer_load_dwordx4 v[108:111], v15, s[24:27], s93 offen sc1
v_mfma_f32_16x16x32_bf16 v[132:135], v[44:47], v[208:211], v[132:135]
ds_read_b64_tr_b16 v[64:65], v20 offset:34816
ds_read_b64_tr_b16 v[66:67], v20 offset:51200
v_mfma_f32_16x16x32_bf16 v[148:151], v[44:47], v[212:215], v[148:151]
ds_read_b64_tr_b16 v[68:69], v21 offset:34816
ds_read_b64_tr_b16 v[70:71], v21 offset:51200
s_bfe_u32 s94, s72, 262164
s_lshl_b32 s94, s94, 15
s_add_u32 s94, s94, s76
s_sub_u32 s94, s94, 2048
buffer_load_dwordx4 v16, s[20:23], s94 offen offset:2048 lds
v_mfma_f32_16x16x32_bf16 v[136:139], v[48:51], v[208:211], v[136:139]
buffer_load_dwordx4 v17, s[20:23], s94 offen offset:3072 lds
v_mfma_f32_16x16x32_bf16 v[152:155], v[48:51], v[212:215], v[152:155]
v_mfma_f32_16x16x32_bf16 v[140:143], v[52:55], v[208:211], v[140:143]
v_mfma_f32_16x16x32_bf16 v[156:159], v[52:55], v[212:215], v[156:159]
s_waitcnt lgkmcnt(0)
s_barrier
v_xor_b32 v18, 65536, v18
v_xor_b32 v19, 65536, v19
v_xor_b32 v20, 65536, v20
v_xor_b32 v21, 65536, v21
v_mfma_f32_16x16x32_bf16 v[128:131], v[56:59], v[216:219], v[128:131]
ds_read_b64_tr_b16 v[40:41], v18 offset:0
ds_read_b64_tr_b16 v[42:43], v18 offset:16384
s_bfe_u32 s93, s72, 262152
s_lshl_b32 s93, s93, 10
s_add_u32 s93, s93, s74
buffer_load_dwordx4 v[112:115], v15, s[24:27], s93 offen sc1
v_and_b32 v23, 15, v1
v_mfma_f32_16x16x32_bf16 v[144:147], v[56:59], v[220:223], v[144:147]
ds_read_b64_tr_b16 v[44:45], v19 offset:0
ds_read_b64_tr_b16 v[46:47], v19 offset:16384
s_add_u32 s93, s93, 73728
buffer_load_dwordx4 v[116:119], v15, s[24:27], s93 offen sc1
v_lshrrev_b32 v24, 4, v1
v_mfma_f32_16x16x32_bf16 v[132:135], v[60:63], v[216:219], v[132:135]
ds_read_b64_tr_b16 v[48:49], v20 offset:0
ds_read_b64_tr_b16 v[50:51], v20 offset:16384
v_and_b32 v25, 7, v1
v_mfma_f32_16x16x32_bf16 v[148:151], v[60:63], v[220:223], v[148:151]
ds_read_b64_tr_b16 v[52:53], v21 offset:0
ds_read_b64_tr_b16 v[54:55], v21 offset:16384
s_add_u32 m0, s48, 98304
s_bfe_u32 s94, s71, 262144
s_lshl_b32 s94, s94, 15
s_add_u32 s94, s94, s77
buffer_load_dwordx4 v16, s[16:19], s94 offen offset:0 lds
v_xor_b32 v24, v24, v25
v_mfma_f32_16x16x32_bf16 v[136:139], v[64:67], v[216:219], v[136:139]
buffer_load_dwordx4 v17, s[16:19], s94 offen offset:1024 lds
v_lshlrev_b32 v24, 4, v24
v_mfma_f32_16x16x32_bf16 v[152:155], v[64:67], v[220:223], v[152:155]
v_lshl_add_u32 v23, v23, 8, v24
v_mfma_f32_16x16x32_bf16 v[140:143], v[68:71], v[216:219], v[140:143]
s_lshl1_add_u32 s53, s41, s42
v_mfma_f32_16x16x32_bf16 v[156:159], v[68:71], v[220:223], v[156:159]
s_waitcnt lgkmcnt(6)
s_waitcnt vmcnt(10)
v_mfma_f32_16x16x32_bf16 v[128:131], v[40:43], v[96:99], v[128:131]
ds_read_b64_tr_b16 v[56:57], v18 offset:2048
ds_read_b64_tr_b16 v[58:59], v18 offset:18432
s_bfe_u32 s93, s72, 262156
s_lshl_b32 s93, s93, 10
s_add_u32 s93, s93, s74
buffer_load_dwordx4 v[120:123], v15, s[24:27], s93 offen sc1
s_lshl_b32 s53, s53, 13
v_mfma_f32_16x16x32_bf16 v[144:147], v[40:43], v[100:103], v[144:147]
ds_read_b64_tr_b16 v[60:61], v19 offset:2048
ds_read_b64_tr_b16 v[62:63], v19 offset:18432
s_add_u32 s93, s93, 73728
buffer_load_dwordx4 v[124:127], v15, s[24:27], s93 offen sc1
s_add_u32 s53, s53, 32768
s_waitcnt lgkmcnt(8)
v_mfma_f32_16x16x32_bf16 v[132:135], v[44:47], v[96:99], v[132:135]
ds_read_b64_tr_b16 v[64:65], v20 offset:2048
ds_read_b64_tr_b16 v[66:67], v20 offset:18432
v_add_u32 v7, s53, v23
v_mfma_f32_16x16x32_bf16 v[148:151], v[44:47], v[100:103], v[148:151]
ds_read_b64_tr_b16 v[68:69], v21 offset:2048
ds_read_b64_tr_b16 v[70:71], v21 offset:18432
s_bfe_u32 s94, s71, 262148
s_lshl_b32 s94, s94, 15
s_add_u32 s94, s94, s77
s_sub_u32 s94, s94, 2048
buffer_load_dwordx4 v16, s[16:19], s94 offen offset:2048 lds
v_xor_b32 v8, 64, v7
s_waitcnt lgkmcnt(10)
v_mfma_f32_16x16x32_bf16 v[136:139], v[48:51], v[96:99], v[136:139]
buffer_load_dwordx4 v17, s[16:19], s94 offen offset:3072 lds
v_lshrrev_b32 v30, 3, v1
v_mfma_f32_16x16x32_bf16 v[152:155], v[48:51], v[100:103], v[152:155]
v_and_b32 v23, 3, v1
s_waitcnt lgkmcnt(8)
v_mfma_f32_16x16x32_bf16 v[140:143], v[52:55], v[96:99], v[140:143]
v_lshlrev_b32 v23, 1, v23
v_mfma_f32_16x16x32_bf16 v[156:159], v[52:55], v[100:103], v[156:159]
v_xor_b32 v23, v23, v30
s_waitcnt lgkmcnt(0)
s_barrier
s_waitcnt vmcnt(10)
v_mfma_f32_16x16x32_bf16 v[128:131], v[56:59], v[104:107], v[128:131]
ds_read_b64_tr_b16 v[40:41], v18 offset:32768
ds_read_b64_tr_b16 v[42:43], v18 offset:49152
s_bfe_u32 s93, s72, 262160
s_lshl_b32 s93, s93, 10
s_add_u32 s93, s93, s74
buffer_load_dwordx4 v[192:195], v15, s[24:27], s93 offen sc1
v_and_b32 v28, 15, v1
v_lshlrev_b32 v28, 2, v28
v_mfma_f32_16x16x32_bf16 v[144:147], v[56:59], v[108:111], v[144:147]
ds_read_b64_tr_b16 v[44:45], v19 offset:32768
ds_read_b64_tr_b16 v[46:47], v19 offset:49152
s_add_u32 s93, s93, 73728
buffer_load_dwordx4 v[196:199], v15, s[24:27], s93 offen sc1
s_lshl1_add_u32 s55, s59, s42
s_lshl_b32 s55, s55, 7
v_mfma_f32_16x16x32_bf16 v[132:135], v[60:63], v[104:107], v[132:135]
ds_read_b64_tr_b16 v[48:49], v20 offset:32768
ds_read_b64_tr_b16 v[50:51], v20 offset:49152
s_add_u32 s55, s55, 65536
buffer_load_dword v26, v28, s[24:27], s55 offen sc1
v_mfma_f32_16x16x32_bf16 v[148:151], v[60:63], v[108:111], v[148:151]
ds_read_b64_tr_b16 v[52:53], v21 offset:32768
ds_read_b64_tr_b16 v[54:55], v21 offset:49152
s_add_u32 m0, s48, 0
s_bfe_u32 s94, s71, 262152
s_lshl_b32 s94, s94, 15
s_add_u32 s94, s94, s77
buffer_load_dwordx4 v16, s[16:19], s94 offen offset:0 lds
buffer_load_dword v27, v28, s[24:27], s55 offen offset:64 sc1
v_mfma_f32_16x16x32_bf16 v[136:139], v[64:67], v[104:107], v[136:139]
buffer_load_dwordx4 v17, s[16:19], s94 offen offset:1024 lds
v_lshlrev_b32 v23, 4, v23
v_bfe_u32 v24, v1, 2, 1
v_mfma_f32_16x16x32_bf16 v[152:155], v[64:67], v[108:111], v[152:155]
v_lshl_add_u32 v23, v24, 7, v23
v_lshl_add_u32 v23, v30, 8, v23
v_mfma_f32_16x16x32_bf16 v[140:143], v[68:71], v[104:107], v[140:143]
s_lshl_b32 s53, s40, 11
s_add_u32 s53, s53, 32768
v_mfma_f32_16x16x32_bf16 v[156:159], v[68:71], v[108:111], v[156:159]
v_add_u32 v9, s53, v23
s_add_u32 s56, s65, 10240
buffer_load_dword v34, v22, s[24:27], s56 offen sc1
s_waitcnt lgkmcnt(6)
s_waitcnt vmcnt(13)
v_mfma_f32_16x16x32_bf16 v[128:131], v[40:43], v[112:115], v[128:131]
ds_read_b64_tr_b16 v[56:57], v18 offset:34816
ds_read_b64_tr_b16 v[58:59], v18 offset:51200
s_bfe_u32 s93, s72, 262164
s_lshl_b32 s93, s93, 10
s_add_u32 s93, s93, s74
buffer_load_dwordx4 v[200:203], v15, s[24:27], s93 offen sc1
v_xor_b32 v10, 16, v9
v_mfma_f32_16x16x32_bf16 v[144:147], v[40:43], v[116:119], v[144:147]
ds_read_b64_tr_b16 v[60:61], v19 offset:34816
ds_read_b64_tr_b16 v[62:63], v19 offset:51200
s_add_u32 s93, s93, 73728
buffer_load_dwordx4 v[204:207], v15, s[24:27], s93 offen sc1
s_lshl_b32 s53, s40, 13
s_waitcnt lgkmcnt(8)
v_mfma_f32_16x16x32_bf16 v[132:135], v[44:47], v[112:115], v[132:135]
ds_read_b64_tr_b16 v[64:65], v20 offset:34816
ds_read_b64_tr_b16 v[66:67], v20 offset:51200
v_lshlrev_b32 v30, 10, v30
v_mfma_f32_16x16x32_bf16 v[148:151], v[44:47], v[116:119], v[148:151]
ds_read_b64_tr_b16 v[68:69], v21 offset:34816
ds_read_b64_tr_b16 v[70:71], v21 offset:51200
s_bfe_u32 s94, s71, 262156
s_lshl_b32 s94, s94, 15
s_add_u32 s94, s94, s77
s_sub_u32 s94, s94, 2048
buffer_load_dwordx4 v16, s[16:19], s94 offen offset:2048 lds
v_lshl_add_u32 v30, v25, 4, v30
s_waitcnt lgkmcnt(10)
v_mfma_f32_16x16x32_bf16 v[136:139], v[48:51], v[112:115], v[136:139]
buffer_load_dwordx4 v17, s[16:19], s94 offen offset:3072 lds
s_lshl_b32 s54, s59, 16
v_mfma_f32_16x16x32_bf16 v[152:155], v[48:51], v[116:119], v[152:155]
s_add_u32 s53, s53, s54
s_waitcnt lgkmcnt(8)
v_mfma_f32_16x16x32_bf16 v[140:143], v[52:55], v[112:115], v[140:143]
s_lshl_b32 s54, s60, 7
v_mfma_f32_16x16x32_bf16 v[156:159], v[52:55], v[116:119], v[156:159]
s_add_u32 s53, s53, s54
s_waitcnt lgkmcnt(0)
s_barrier
v_xor_b32 v18, 65536, v18
v_xor_b32 v19, 65536, v19
v_xor_b32 v20, 65536, v20
v_xor_b32 v21, 65536, v21
s_waitcnt vmcnt(4)
v_cmp_ne_u32 vcc, s58, v34
s_nop 0
s_cbranch_vccz Lok43
s_add_u32 s56, s65, 10240
s_mov_b32 s69, 0
Lsp44:
buffer_load_dword v34, v22, s[24:27], s56 offen sc1
s_add_u32 s69, s69, 1
s_waitcnt vmcnt(0)
v_cmp_ne_u32 vcc, s58, v34
s_cmp_ge_u32 s69, 0x100000
s_cbranch_scc1 Lok43
s_cbranch_vccnz Lsp44
Lok43:
v_mfma_f32_16x16x32_bf16 v[128:131], v[56:59], v[120:123], v[128:131]
ds_read_b64_tr_b16 v[40:41], v18 offset:0
ds_read_b64_tr_b16 v[42:43], v18 offset:16384
s_bfe_u32 s93, s71, 262144
s_lshl_b32 s93, s93, 10
s_add_u32 s93, s93, s75
buffer_load_dwordx4 v[208:211], v15, s[24:27], s93 offen sc1
v_mfma_f32_16x16x32_bf16 v[144:147], v[56:59], v[124:127], v[144:147]
ds_read_b64_tr_b16 v[44:45], v19 offset:0
ds_read_b64_tr_b16 v[46:47], v19 offset:16384
v_mfma_f32_16x16x32_bf16 v[132:135], v[60:63], v[120:123], v[132:135]
ds_read_b64_tr_b16 v[48:49], v20 offset:0
ds_read_b64_tr_b16 v[50:51], v20 offset:16384
v_mfma_f32_16x16x32_bf16 v[148:151], v[60:63], v[124:127], v[148:151]
ds_read_b64_tr_b16 v[52:53], v21 offset:0
ds_read_b64_tr_b16 v[54:55], v21 offset:16384
s_add_u32 s93, s93, 73728
buffer_load_dwordx4 v[212:215], v15, s[24:27], s93 offen sc1
v_mfma_f32_16x16x32_bf16 v[136:139], v[64:67], v[120:123], v[136:139]
v_mfma_f32_16x16x32_bf16 v[152:155], v[64:67], v[124:127], v[152:155]
v_mfma_f32_16x16x32_bf16 v[140:143], v[68:71], v[120:123], v[140:143]
v_mfma_f32_16x16x32_bf16 v[156:159], v[68:71], v[124:127], v[156:159]
s_waitcnt lgkmcnt(6)
v_mfma_f32_16x16x32_bf16 v[128:131], v[40:43], v[192:195], v[128:131]
ds_read_b64_tr_b16 v[56:57], v18 offset:2048
ds_read_b64_tr_b16 v[58:59], v18 offset:18432
s_bfe_u32 s93, s71, 262148
s_lshl_b32 s93, s93, 10
s_add_u32 s93, s93, s75
buffer_load_dwordx4 v[216:219], v15, s[24:27], s93 offen sc1
v_mfma_f32_16x16x32_bf16 v[144:147], v[40:43], v[196:199], v[144:147]
ds_read_b64_tr_b16 v[60:61], v19 offset:2048
ds_read_b64_tr_b16 v[62:63], v19 offset:18432
s_waitcnt lgkmcnt(8)
v_mfma_f32_16x16x32_bf16 v[132:135], v[44:47], v[192:195], v[132:135]
ds_read_b64_tr_b16 v[64:65], v20 offset:2048
ds_read_b64_tr_b16 v[66:67], v20 offset:18432
v_sub_f32 v28, 1.0, v26
v_mfma_f32_16x16x32_bf16 v[148:151], v[44:47], v[196:199], v[148:151]
ds_read_b64_tr_b16 v[68:69], v21 offset:2048
ds_read_b64_tr_b16 v[70:71], v21 offset:18432
s_add_u32 s93, s93, 73728
buffer_load_dwordx4 v[220:223], v15, s[24:27], s93 offen sc1
s_waitcnt lgkmcnt(10)
v_mfma_f32_16x16x32_bf16 v[136:139], v[48:51], v[192:195], v[136:139]
v_mfma_f32_16x16x32_bf16 v[152:155], v[48:51], v[196:199], v[152:155]
v_sub_f32 v29, 1.0, v27
s_waitcnt lgkmcnt(8)
v_mfma_f32_16x16x32_bf16 v[140:143], v[52:55], v[192:195], v[140:143]
v_mfma_f32_16x16x32_bf16 v[156:159], v[52:55], v[196:199], v[156:159]
s_waitcnt lgkmcnt(0)
s_barrier
s_waitcnt vmcnt(6)
v_mfma_f32_16x16x32_bf16 v[128:131], v[56:59], v[200:203], v[128:131]
ds_read_b64_tr_b16 v[40:41], v18 offset:32768
ds_read_b64_tr_b16 v[42:43], v18 offset:49152
s_bfe_u32 s93, s71, 262152
s_lshl_b32 s93, s93, 10
s_add_u32 s93, s93, s75
buffer_load_dwordx4 v[96:99], v15, s[24:27], s93 offen sc1
v_mfma_f32_16x16x32_bf16 v[144:147], v[56:59], v[204:207], v[144:147]
ds_read_b64_tr_b16 v[44:45], v19 offset:32768
ds_read_b64_tr_b16 v[46:47], v19 offset:49152
v_mfma_f32_16x16x32_bf16 v[132:135], v[60:63], v[200:203], v[132:135]
ds_read_b64_tr_b16 v[48:49], v20 offset:32768
ds_read_b64_tr_b16 v[50:51], v20 offset:49152
v_mfma_f32_16x16x32_bf16 v[148:151], v[60:63], v[204:207], v[148:151]
ds_read_b64_tr_b16 v[52:53], v21 offset:32768
ds_read_b64_tr_b16 v[54:55], v21 offset:49152
s_add_u32 s93, s93, 73728
buffer_load_dwordx4 v[100:103], v15, s[24:27], s93 offen sc1
v_mfma_f32_16x16x32_bf16 v[136:139], v[64:67], v[200:203], v[136:139]
v_mfma_f32_16x16x32_bf16 v[152:155], v[64:67], v[204:207], v[152:155]
v_mfma_f32_16x16x32_bf16 v[140:143], v[68:71], v[200:203], v[140:143]
v_mfma_f32_16x16x32_bf16 v[156:159], v[68:71], v[204:207], v[156:159]
s_waitcnt lgkmcnt(6)
s_waitcnt vmcnt(4)
v_mfma_f32_16x16x32_bf16 v[160:163], v[40:43], v[208:211], 0
ds_read_b64_tr_b16 v[56:57], v18 offset:34816
ds_read_b64_tr_b16 v[58:59], v18 offset:51200
s_bfe_u32 s93, s71, 262156
s_lshl_b32 s93, s93, 10
s_add_u32 s93, s93, s75
buffer_load_dwordx4 v[104:107], v15, s[24:27], s93 offen sc1
v_mul_f32 v128, v128, v28
v_mul_f32 v129, v129, v28
v_mfma_f32_16x16x32_bf16 v[176:179], v[40:43], v[212:215], 0
ds_read_b64_tr_b16 v[60:61], v19 offset:34816
ds_read_b64_tr_b16 v[62:63], v19 offset:51200
v_mul_f32 v130, v130, v28
v_mul_f32 v131, v131, v28
s_waitcnt lgkmcnt(8)
v_mfma_f32_16x16x32_bf16 v[164:167], v[44:47], v[208:211], 0
ds_read_b64_tr_b16 v[64:65], v20 offset:34816
ds_read_b64_tr_b16 v[66:67], v20 offset:51200
v_mul_f32 v132, v132, v28
v_mul_f32 v133, v133, v28
v_mfma_f32_16x16x32_bf16 v[180:183], v[44:47], v[212:215], 0
ds_read_b64_tr_b16 v[68:69], v21 offset:34816
ds_read_b64_tr_b16 v[70:71], v21 offset:51200
s_add_u32 s93, s93, 73728
buffer_load_dwordx4 v[108:111], v15, s[24:27], s93 offen sc1
v_mul_f32 v134, v134, v28
v_mul_f32 v135, v135, v28
s_waitcnt lgkmcnt(10)
v_mfma_f32_16x16x32_bf16 v[168:171], v[48:51], v[208:211], 0
v_mul_f32 v136, v136, v28
v_mul_f32 v137, v137, v28
v_mfma_f32_16x16x32_bf16 v[184:187], v[48:51], v[212:215], 0
v_mul_f32 v138, v138, v28
v_mul_f32 v139, v139, v28
s_waitcnt lgkmcnt(8)
v_mfma_f32_16x16x32_bf16 v[172:175], v[52:55], v[208:211], 0
v_mul_f32 v140, v140, v28
v_mul_f32 v141, v141, v28
v_mfma_f32_16x16x32_bf16 v[188:191], v[52:55], v[212:215], 0
v_mul_f32 v142, v142, v28
v_mul_f32 v143, v143, v28
s_waitcnt lgkmcnt(0)
s_barrier
v_xor_b32 v18, 65536, v18
v_xor_b32 v19, 65536, v19
v_xor_b32 v20, 65536, v20
v_xor_b32 v21, 65536, v21
s_waitcnt vmcnt(4)
v_mfma_f32_16x16x32_bf16 v[160:163], v[56:59], v[216:219], v[160:163]
ds_read_b64_tr_b16 v[40:41], v18 offset:0
ds_read_b64_tr_b16 v[42:43], v18 offset:16384
v_mul_f32 v144, v144, v29
v_mul_f32 v145, v145, v29
v_mfma_f32_16x16x32_bf16 v[176:179], v[56:59], v[220:223], v[176:179]
ds_read_b64_tr_b16 v[56:57], v18 offset:2048
ds_read_b64_tr_b16 v[58:59], v18 offset:18432
ds_read_b64_tr_b16 v[44:45], v19 offset:0
ds_read_b64_tr_b16 v[46:47], v19 offset:16384
v_mul_f32 v146, v146, v29
v_mul_f32 v147, v147, v29
v_mfma_f32_16x16x32_bf16 v[164:167], v[60:63], v[216:219], v[164:167]
ds_read_b64_tr_b16 v[48:49], v20 offset:0
ds_read_b64_tr_b16 v[50:51], v20 offset:16384
v_mul_f32 v148, v148, v29
v_mul_f32 v149, v149, v29
v_mfma_f32_16x16x32_bf16 v[180:183], v[60:63], v[220:223], v[180:183]
ds_read_b64_tr_b16 v[60:61], v19 offset:2048
ds_read_b64_tr_b16 v[62:63], v19 offset:18432
ds_read_b64_tr_b16 v[52:53], v21 offset:0
ds_read_b64_tr_b16 v[54:55], v21 offset:16384
v_mul_f32 v150, v150, v29
v_mul_f32 v151, v151, v29
v_mfma_f32_16x16x32_bf16 v[168:171], v[64:67], v[216:219], v[168:171]
v_mul_f32 v152, v152, v29
v_mul_f32 v153, v153, v29
v_mfma_f32_16x16x32_bf16 v[184:187], v[64:67], v[220:223], v[184:187]
ds_read_b64_tr_b16 v[64:65], v20 offset:2048
ds_read_b64_tr_b16 v[66:67], v20 offset:18432
v_mul_f32 v154, v154, v29
v_mul_f32 v155, v155, v29
v_mfma_f32_16x16x32_bf16 v[172:175], v[68:71], v[216:219], v[172:175]
v_mul_f32 v156, v156, v29
v_mul_f32 v157, v157, v29
v_mfma_f32_16x16x32_bf16 v[188:191], v[68:71], v[220:223], v[188:191]
ds_read_b64_tr_b16 v[68:69], v21 offset:2048
ds_read_b64_tr_b16 v[70:71], v21 offset:18432
v_mul_f32 v158, v158, v29
v_mul_f32 v159, v159, v29
s_waitcnt lgkmcnt(14)
s_waitcnt vmcnt(2)
v_mfma_f32_16x16x32_bf16 v[160:163], v[40:43], v[96:99], v[160:163]
v_mfma_f32_16x16x32_bf16 v[176:179], v[40:43], v[100:103], v[176:179]
s_waitcnt lgkmcnt(12)
s_waitcnt vmcnt(0)
v_mfma_f32_16x16x32_bf16 v[160:163], v[56:59], v[104:107], v[160:163]
v_mfma_f32_16x16x32_bf16 v[176:179], v[56:59], v[108:111], v[176:179]
s_waitcnt lgkmcnt(10)
v_mfma_f32_16x16x32_bf16 v[164:167], v[44:47], v[96:99], v[164:167]
v_mfma_f32_16x16x32_bf16 v[180:183], v[44:47], v[100:103], v[180:183]
s_nop 3
v_fmac_f32 v128, v160, v26
v_fmac_f32 v129, v161, v26
v_fmac_f32 v130, v162, v26
v_fmac_f32 v131, v163, v26
ds_write_b128 v7, v[128:131] offset:0
s_waitcnt lgkmcnt(7)
v_mfma_f32_16x16x32_bf16 v[164:167], v[60:63], v[104:107], v[164:167]
v_mfma_f32_16x16x32_bf16 v[180:183], v[60:63], v[108:111], v[180:183]
v_fmac_f32 v144, v176, v27
v_fmac_f32 v145, v177, v27
v_fmac_f32 v146, v178, v27
v_fmac_f32 v147, v179, v27
ds_write_b128 v7, v[144:147] offset:4096
v_mfma_f32_16x16x32_bf16 v[168:171], v[48:51], v[96:99], v[168:171]
v_mfma_f32_16x16x32_bf16 v[184:187], v[48:51], v[100:103], v[184:187]
v_fmac_f32 v132, v164, v26
v_fmac_f32 v133, v165, v26
v_fmac_f32 v134, v166, v26
v_fmac_f32 v135, v167, v26
ds_write_b128 v8, v[132:135] offset:0
s_waitcnt lgkmcnt(5)
v_mfma_f32_16x16x32_bf16 v[168:171], v[64:67], v[104:107], v[168:171]
v_mfma_f32_16x16x32_bf16 v[184:187], v[64:67], v[108:111], v[184:187]
v_fmac_f32 v148, v180, v27
v_fmac_f32 v149, v181, v27
v_fmac_f32 v150, v182, v27
v_fmac_f32 v151, v183, v27
ds_write_b128 v8, v[148:151] offset:4096
v_mfma_f32_16x16x32_bf16 v[172:175], v[52:55], v[96:99], v[172:175]
v_mfma_f32_16x16x32_bf16 v[188:191], v[52:55], v[100:103], v[188:191]
v_fmac_f32 v136, v168, v26
v_fmac_f32 v137, v169, v26
v_fmac_f32 v138, v170, v26
v_fmac_f32 v139, v171, v26
ds_write_b128 v7, v[136:139] offset:128
s_waitcnt lgkmcnt(5)
v_mfma_f32_16x16x32_bf16 v[172:175], v[68:71], v[104:107], v[172:175]
v_mfma_f32_16x16x32_bf16 v[188:191], v[68:71], v[108:111], v[188:191]
v_fmac_f32 v152, v184, v27
v_fmac_f32 v153, v185, v27
v_fmac_f32 v154, v186, v27
v_fmac_f32 v155, v187, v27
ds_write_b128 v7, v[152:155] offset:4224
s_nop 1
v_fmac_f32 v140, v172, v26
v_fmac_f32 v141, v173, v26
v_fmac_f32 v142, v174, v26
v_fmac_f32 v143, v175, v26
ds_write_b128 v8, v[140:143] offset:128
v_fmac_f32 v156, v188, v27
v_fmac_f32 v157, v189, v27
v_fmac_f32 v158, v190, v27
v_fmac_f32 v159, v191, v27
ds_write_b128 v8, v[156:159] offset:4224
s_waitcnt lgkmcnt(0)
s_barrier
ds_read_b128 v[192:195], v9 offset:0
ds_read_b128 v[196:199], v10 offset:0
ds_read_b128 v[200:203], v9 offset:16384
ds_read_b128 v[204:207], v10 offset:16384
ds_read_b128 v[208:211], v9 offset:32768
ds_read_b128 v[212:215], v10 offset:32768
ds_read_b128 v[216:219], v9 offset:49152
ds_read_b128 v[220:223], v10 offset:49152
s_waitcnt lgkmcnt(4)
v_add_f32 v192, v192, v200
v_add_f32 v193, v193, v201
v_add_f32 v194, v194, v202
v_add_f32 v195, v195, v203
v_add_f32 v196, v196, v204
v_add_f32 v197, v197, v205
v_add_f32 v198, v198, v206
v_add_f32 v199, v199, v207
s_waitcnt lgkmcnt(0)
v_add_f32 v208, v208, v216
v_add_f32 v209, v209, v217
v_add_f32 v210, v210, v218
v_add_f32 v211, v211, v219
v_add_f32 v212, v212, v220
v_add_f32 v213, v213, v221
v_add_f32 v214, v214, v222
v_add_f32 v215, v215, v223
v_add_f32 v192, v192, v208
v_add_f32 v193, v193, v209
v_add_f32 v194, v194, v210
v_add_f32 v195, v195, v211
v_add_f32 v196, v196, v212
v_add_f32 v197, v197, v213
v_add_f32 v198, v198, v214
v_add_f32 v199, v199, v215
v_cvt_pk_bf16_f32 v192, v192, v193
v_cvt_pk_bf16_f32 v193, v194, v195
v_cvt_pk_bf16_f32 v194, v196, v197
v_cvt_pk_bf16_f32 v195, v198, v199
buffer_store_dwordx4 v[192:195], v30, s[28:31], s53 offen sc1
s_endpgm
Lend:
s_endpgm
.section .rodata,"a"
.p2align 6
.amdhsa_kernel gated_mix__linear_attn_block__dense_activation_relu__prompt_kernel
  .amdhsa_next_free_vgpr 256
  .amdhsa_next_free_sgpr 102
  .amdhsa_accum_offset 256
  .amdhsa_group_segment_fixed_size 0
  .amdhsa_kernarg_size 80
  .amdhsa_user_sgpr_count 2
  .amdhsa_user_sgpr_kernarg_segment_ptr 1
  .amdhsa_system_sgpr_workgroup_id_x 1
.end_amdhsa_kernel
```
